```python
import torch

def _softmax(x, axis=-1):
    return torch.softmax(x, dim=axis)
def _gelu(x):
    return torch.nn.functional.gelu(x, approximate="tanh")
def _silu(x):
    return torch.nn.functional.silu(x)
def _sigmoid(x):
    return torch.sigmoid(x)
def _layernorm(x, axis=-1, eps=1e-5):
    m = x.mean(dim=axis, keepdim=True)
    v = x.var(dim=axis, keepdim=True, unbiased=False)
    return (x - m) / torch.sqrt(v + eps)
def _scatter_add(tgt, idx, src, axis=0):
    return tgt.clone().index_add_(axis, idx, src)
def _segment_sum(src, seg, n):
    out = torch.zeros((n,) + src.shape[1:], dtype=src.dtype)
    return out.index_add_(0, seg, src)
def _pad(x, pw):
    flat = tuple(v for pair in reversed(pw) for v in pair)
    return torch.nn.functional.pad(x, flat)

kernel_name = 'sequential_preLN__mha_block_cached__geglu_ffn__decode'

def setup_inputs():

    _w = (lambda a: (lambda t: t.to(torch.bfloat16) if t.is_floating_point() else t)(torch.as_tensor(a)))
    def _A_setup():
        B, Sq, D = 2, 1, 512
        H, Sk, Dh = 32, 8192, 128
        return {
            "x": _w((lambda *s: torch.randn(*s, dtype=torch.bfloat16) * 0.05)(B, Sq, D)),
            "k_cache": _w((lambda *s: torch.randn(*s, dtype=torch.bfloat16) * 3.2)(B, H, Sk, Dh)),
            "v_cache": _w((lambda *s: torch.randn(*s, dtype=torch.bfloat16) * 0.4)(B, H, Sk, Dh)),
            "wq": _w((lambda *s: torch.randn(*s, dtype=torch.bfloat16) * 3.2)(D, H * Dh) * (D ** -0.5)),
            "wo": _w((lambda *s: torch.randn(*s, dtype=torch.bfloat16) * 0.4)(H * Dh, D) * ((H * Dh) ** -0.5)),
        }
    _A_in = _A_setup()

    def _B_setup():
        B, S, D, F = 2, 1, 512, 1376
        return {
            "x": _w((lambda *s: torch.randn(*s, dtype=torch.bfloat16) * 0.05)(B, S, D)),
            "w_gate": _w((lambda *s: torch.randn(*s, dtype=torch.bfloat16) * 0.05)(D, F)),
            "w_up": _w((lambda *s: torch.randn(*s, dtype=torch.bfloat16) * 0.05)(D, F)),
            "w_down": _w((lambda *s: torch.randn(*s, dtype=torch.bfloat16) * 0.05)(F, D)),
        }
    _B_in = _B_setup()

    return {
        "A_x": _A_in["x"],
        "A_k_cache": _A_in["k_cache"],
        "A_v_cache": _A_in["v_cache"],
        "A_wq": _A_in["wq"],
        "A_wo": _A_in["wo"],
        "B_x": _B_in["x"],
        "B_w_gate": _B_in["w_gate"],
        "B_w_up": _B_in["w_up"],
        "B_w_down": _B_in["w_down"],
    }

def reference(A_x, A_k_cache, A_v_cache, A_wq, A_wo, B_x, B_w_gate, B_w_up, B_w_down):
    def _A_ref(x, k_cache, v_cache, wq, wo):
        B, Sq, D = x.shape
        H, Dh = 32, 128
        q = (lambda x, *d: x.permute(*d))((x @ wq).reshape(B, Sq, H, Dh), 0, 2, 1, 3)
        scores = torch.einsum("bhqd,bhkd->bhqk", q, k_cache) * (Dh ** -0.5)
        p = _softmax(scores, axis=-1)
        o = torch.einsum("bhqk,bhkd->bhqd", p, v_cache)
        return (lambda x, *d: x.permute(*d))(o, 0, 2, 1, 3).reshape(B, Sq, H * Dh) @ wo

    def _B_ref(x, w_gate, w_up, w_down):
        return (_gelu(x @ w_gate) * (x @ w_up)) @ w_down

    x = A_x
    h = x + _A_ref(_layernorm(x, axis=-1), A_k_cache, A_v_cache, A_wq, A_wo)
    h2 = h + _B_ref(_layernorm(h, axis=-1), B_w_gate, B_w_up, B_w_down)
    return h2
```

```asm
; @launch grid=(256,1,1) block=(512,1,1) lds=139264
.amdgcn_target "amdgcn-amd-amdhsa--gfx950"
.text
.globl sequential_preLN__mha_block_cached__geglu_ffn__decode_kernel
.p2align 8
.type sequential_preLN__mha_block_cached__geglu_ffn__decode_kernel,@function
sequential_preLN__mha_block_cached__geglu_ffn__decode_kernel:
  s_load_dwordx16 s[16:31], s[0:1], 0
  s_load_dwordx8 s[32:39], s[0:1], 64
  v_lshrrev_b32 v1, 6, v0
  v_and_b32 v0, 63, v0
  s_and_b32 s4, s2, 7
  v_readfirstlane_b32 s3, v1
  s_cmp_lt_u32 s2, 64
  s_cbranch_scc1 L_service
  s_cmp_ge_u32 s2, 256
  s_cbranch_scc1 L_exit
  s_lshr_b32 s10, s2, 3
  s_sub_u32 s10, s10, 8
  s_mul_i32 s11, s10, 43
  s_lshr_b32 s11, s11, 7
  s_mul_i32 s5, s11, 3
  s_sub_u32 s5, s10, s5
  s_lshl_b32 s8, s11, 3
  s_add_u32 s8, s8, s4
  s_cmp_ge_u32 s3, 4
  s_cbranch_scc1 L_shelper
  s_lshl_b32 s11, s8, 21
  s_add_u32 s42, s11, 0x200000
  s_mul_i32 s12, s5, 704512
  s_add_u32 s11, s11, s12
  s_lshl_b32 s13, s3, 12
  s_add_u32 s11, s11, s13
  v_lshl_add_u32 v1, v0, 4, s11
  s_mov_b32 s43, 0x20000
  s_mov_b32 s14, 0
  s_movk_i32 s15, 0x4000
  s_waitcnt lgkmcnt(0)
  s_mov_b32 s40, s18
  s_mov_b32 s41, s19
  buffer_load_dwordx4 v[64:67], v1, s[40:43], s14 offen nt
  buffer_load_dwordx4 v[68:71], v1, s[40:43], s14 offen offset:1024 nt
  buffer_load_dwordx4 v[72:75], v1, s[40:43], s14 offen offset:2048 nt
  buffer_load_dwordx4 v[76:79], v1, s[40:43], s14 offen offset:3072 nt
  s_add_u32 s14, s14, s15
  buffer_load_dwordx4 v[80:83], v1, s[40:43], s14 offen nt
  buffer_load_dwordx4 v[84:87], v1, s[40:43], s14 offen offset:1024 nt
  buffer_load_dwordx4 v[88:91], v1, s[40:43], s14 offen offset:2048 nt
  s_mov_b32 s44, s20
  s_mov_b32 s45, s21
  s_mov_b32 s46, s42
  s_mov_b32 s47, 0x20000
  v_and_b32 v36, 7, v0
  v_lshrrev_b32 v37, 1, v36
  v_and_b32 v38, 1, v36
  v_lshlrev_b32 v38, 4, v38
  v_mov_b32 v39, 0xffff
  v_lshlrev_b32 v39, v38, v39
  v_cmp_eq_u32 vcc, 0, v37
  s_nop 1
  v_cndmask_b32 v6, 0, v39, vcc
  v_cmp_eq_u32 vcc, 1, v37
  s_nop 1
  v_cndmask_b32 v7, 0, v39, vcc
  v_cmp_eq_u32 vcc, 2, v37
  s_nop 1
  v_cndmask_b32 v8, 0, v39, vcc
  v_cmp_eq_u32 vcc, 3, v37
  s_nop 1
  v_cndmask_b32 v9, 0, v39, vcc
  s_mov_b32 s64, 0xaaaaaaaa
  s_mov_b32 s65, 0xaaaaaaaa
  s_mov_b32 s66, 0xcccccccc
  s_mov_b32 s67, 0xcccccccc
  s_mov_b32 s68, 0x3db504f3
  s_mov_b32 s69, 0x3fb8aa3b
  v_and_b32 v46, 15, v0
  v_lshlrev_b32 v46, 4, v46
  s_cmp_eq_u32 s5, 2
  s_mov_b32 s60, 0x77777777
  s_cselect_b32 s60, 0x33333333, s60
  s_mov_b32 s61, s60
  v_and_b32 v50, 15, v0
  v_lshlrev_b32 v50, 5, v50
  v_bfe_u32 v51, v0, 4, 1
  v_lshl_add_u32 v50, v51, 4, v50
  s_lshl_b32 s13, s3, 9
  v_add_u32 v50, s13, v50
  s_lshl_b32 s13, s3, 3
  v_mov_b32 v51, s13
  s_mul_i32 s13, s3, 32768
  v_lshl_add_u32 v47, v0, 4, s13
  s_waitcnt vmcnt(6)
  buffer_load_dwordx4 v[92:95], v1, s[40:43], s14 offen offset:3072 nt
  s_waitcnt vmcnt(6)
  s_add_u32 s14, s14, s15
  buffer_load_dwordx4 v[96:99], v1, s[40:43], s14 offen nt
  s_waitcnt vmcnt(6)
  buffer_load_dwordx4 v[100:103], v1, s[40:43], s14 offen offset:1024 nt
  s_waitcnt vmcnt(6)
  buffer_load_dwordx4 v[104:107], v1, s[40:43], s14 offen offset:2048 nt
  s_waitcnt vmcnt(6)
  buffer_load_dwordx4 v[108:111], v1, s[40:43], s14 offen offset:3072 nt
  s_waitcnt vmcnt(6)
  s_add_u32 s14, s14, s15
  buffer_load_dwordx4 v[112:115], v1, s[40:43], s14 offen nt
  s_waitcnt vmcnt(6)
  buffer_load_dwordx4 v[116:119], v1, s[40:43], s14 offen offset:1024 nt
  s_waitcnt vmcnt(6)
  buffer_load_dwordx4 v[120:123], v1, s[40:43], s14 offen offset:2048 nt
  s_waitcnt vmcnt(6)
  buffer_load_dwordx4 v[124:127], v1, s[40:43], s14 offen offset:3072 nt
  s_waitcnt vmcnt(6)
  s_add_u32 s14, s14, s15
  buffer_load_dwordx4 v[128:131], v1, s[40:43], s14 offen nt
  s_waitcnt vmcnt(6)
  buffer_load_dwordx4 v[132:135], v1, s[40:43], s14 offen offset:1024 nt
  s_waitcnt vmcnt(6)
  buffer_load_dwordx4 v[136:139], v1, s[40:43], s14 offen offset:2048 nt
  s_waitcnt vmcnt(6)
  buffer_load_dwordx4 v[140:143], v1, s[40:43], s14 offen offset:3072 nt
  s_waitcnt vmcnt(6)
  s_add_u32 s14, s14, s15
  buffer_load_dwordx4 v[144:147], v1, s[40:43], s14 offen nt
  s_waitcnt vmcnt(6)
  buffer_load_dwordx4 v[148:151], v1, s[40:43], s14 offen offset:1024 nt
  s_waitcnt vmcnt(6)
  buffer_load_dwordx4 v[152:155], v1, s[40:43], s14 offen offset:2048 nt
  s_waitcnt vmcnt(6)
  buffer_load_dwordx4 v[156:159], v1, s[40:43], s14 offen offset:3072 nt
  s_waitcnt vmcnt(6)
  s_add_u32 s14, s14, s15
  buffer_load_dwordx4 v[160:163], v1, s[40:43], s14 offen nt
  s_waitcnt vmcnt(6)
  buffer_load_dwordx4 v[164:167], v1, s[40:43], s14 offen offset:1024 nt
  s_waitcnt vmcnt(6)
  buffer_load_dwordx4 v[168:171], v1, s[40:43], s14 offen offset:2048 nt
  s_waitcnt vmcnt(6)
  buffer_load_dwordx4 v[172:175], v1, s[40:43], s14 offen offset:3072 nt
  s_waitcnt vmcnt(6)
  s_add_u32 s14, s14, s15
  buffer_load_dwordx4 v[176:179], v1, s[40:43], s14 offen nt
  s_waitcnt vmcnt(6)
  buffer_load_dwordx4 v[180:183], v1, s[40:43], s14 offen offset:1024 nt
  s_waitcnt vmcnt(6)
  buffer_load_dwordx4 v[184:187], v1, s[40:43], s14 offen offset:2048 nt
  s_waitcnt vmcnt(6)
  buffer_load_dwordx4 v[188:191], v1, s[40:43], s14 offen offset:3072 nt
  s_waitcnt vmcnt(6)
  s_add_u32 s14, s14, s15
  buffer_load_dwordx4 v[192:195], v1, s[40:43], s14 offen nt
  s_waitcnt vmcnt(6)
  buffer_load_dwordx4 v[196:199], v1, s[40:43], s14 offen offset:1024 nt
  s_waitcnt vmcnt(6)
  buffer_load_dwordx4 v[200:203], v1, s[40:43], s14 offen offset:2048 nt
  s_waitcnt vmcnt(6)
  buffer_load_dwordx4 v[204:207], v1, s[40:43], s14 offen offset:3072 nt
  s_waitcnt vmcnt(6)
  s_add_u32 s14, s14, s15
  buffer_load_dwordx4 v[208:211], v1, s[40:43], s14 offen nt
  s_waitcnt vmcnt(6)
  buffer_load_dwordx4 v[212:215], v1, s[40:43], s14 offen offset:1024 nt
  s_waitcnt vmcnt(6)
  buffer_load_dwordx4 v[216:219], v1, s[40:43], s14 offen offset:2048 nt
  s_waitcnt vmcnt(6)
  buffer_load_dwordx4 v[220:223], v1, s[40:43], s14 offen offset:3072 nt
  s_waitcnt vmcnt(6)
  s_add_u32 s14, s14, s15
  buffer_load_dwordx4 v[224:227], v1, s[40:43], s14 offen nt
  s_waitcnt vmcnt(6)
  buffer_load_dwordx4 v[228:231], v1, s[40:43], s14 offen offset:1024 nt
  s_waitcnt vmcnt(6)
  buffer_load_dwordx4 v[232:235], v1, s[40:43], s14 offen offset:2048 nt
  s_waitcnt vmcnt(6)
  buffer_load_dwordx4 v[236:239], v1, s[40:43], s14 offen offset:3072 nt
  s_waitcnt vmcnt(6)
  s_add_u32 s14, s14, s15
  buffer_load_dwordx4 v[240:243], v1, s[40:43], s14 offen nt
  s_waitcnt vmcnt(6)
  buffer_load_dwordx4 v[244:247], v1, s[40:43], s14 offen offset:1024 nt
  s_waitcnt vmcnt(6)
  buffer_load_dwordx4 v[248:251], v1, s[40:43], s14 offen offset:2048 nt
  s_waitcnt vmcnt(6)
  buffer_load_dwordx4 v[252:255], v1, s[40:43], s14 offen offset:3072 nt
  s_waitcnt vmcnt(6)
  s_add_u32 s14, s14, s15
  s_add_u32 m0, s13, 8192
  s_nop 0
  buffer_load_dwordx4 v1, s[40:43], s14 offen nt lds
  s_waitcnt vmcnt(6)
  buffer_load_dwordx4 v1, s[40:43], s14 offen offset:1024 nt lds
  s_waitcnt vmcnt(6)
  buffer_load_dwordx4 v1, s[40:43], s14 offen offset:2048 nt lds
  s_waitcnt vmcnt(6)
  buffer_load_dwordx4 v1, s[40:43], s14 offen offset:3072 nt lds
  s_waitcnt vmcnt(6)
  s_add_u32 s14, s14, s15
  s_add_u32 m0, s13, 12288
  s_nop 0
  buffer_load_dwordx4 v1, s[40:43], s14 offen nt lds
  s_waitcnt vmcnt(6)
  buffer_load_dwordx4 v1, s[40:43], s14 offen offset:1024 nt lds
  s_waitcnt vmcnt(6)
  buffer_load_dwordx4 v1, s[40:43], s14 offen offset:2048 nt lds
  s_waitcnt vmcnt(6)
  buffer_load_dwordx4 v1, s[40:43], s14 offen offset:3072 nt lds
  s_waitcnt vmcnt(6)
  s_add_u32 s14, s14, s15
  s_add_u32 m0, s13, 16384
  s_nop 0
  buffer_load_dwordx4 v1, s[40:43], s14 offen nt lds
  s_waitcnt vmcnt(6)
  buffer_load_dwordx4 v1, s[40:43], s14 offen offset:1024 nt lds
  s_waitcnt vmcnt(6)
  buffer_load_dwordx4 v1, s[40:43], s14 offen offset:2048 nt lds
  s_waitcnt vmcnt(6)
  buffer_load_dwordx4 v1, s[40:43], s14 offen offset:3072 nt lds
  s_waitcnt vmcnt(6)
  s_add_u32 s14, s14, s15
  s_add_u32 m0, s13, 20480
  s_nop 0
  buffer_load_dwordx4 v1, s[40:43], s14 offen nt lds
  s_waitcnt vmcnt(6)
  buffer_load_dwordx4 v1, s[40:43], s14 offen offset:1024 nt lds
  s_waitcnt vmcnt(6)
  buffer_load_dwordx4 v1, s[40:43], s14 offen offset:2048 nt lds
  s_waitcnt vmcnt(6)
  buffer_load_dwordx4 v1, s[40:43], s14 offen offset:3072 nt lds
  s_waitcnt vmcnt(6)
  s_add_u32 s14, s14, s15
  s_add_u32 m0, s13, 24576
  s_nop 0
  buffer_load_dwordx4 v1, s[40:43], s14 offen nt lds
  s_waitcnt vmcnt(6)
  buffer_load_dwordx4 v1, s[40:43], s14 offen offset:1024 nt lds
  s_waitcnt vmcnt(6)
  buffer_load_dwordx4 v1, s[40:43], s14 offen offset:2048 nt lds
  s_waitcnt vmcnt(6)
  buffer_load_dwordx4 v1, s[40:43], s14 offen offset:3072 nt lds
  s_waitcnt vmcnt(6)
  s_add_u32 s14, s14, s15
  s_add_u32 m0, s13, 28672
  s_nop 0
  buffer_load_dwordx4 v1, s[40:43], s14 offen nt lds
  s_waitcnt vmcnt(6)
  buffer_load_dwordx4 v1, s[40:43], s14 offen offset:1024 nt lds
  s_waitcnt vmcnt(6)
  buffer_load_dwordx4 v1, s[40:43], s14 offen offset:2048 nt lds
  s_waitcnt vmcnt(6)
  buffer_load_dwordx4 v1, s[40:43], s14 offen offset:3072 nt lds
  s_waitcnt vmcnt(6)
  s_add_u32 s14, s14, s15
  s_add_u32 m0, s13, 32768
  s_nop 0
  buffer_load_dwordx4 v1, s[40:43], s14 offen nt lds
  s_waitcnt vmcnt(6)
  buffer_load_dwordx4 v1, s[40:43], s14 offen offset:1024 nt lds
  s_waitcnt vmcnt(6)
  buffer_load_dwordx4 v1, s[40:43], s14 offen offset:2048 nt lds
  s_waitcnt vmcnt(6)
  buffer_load_dwordx4 v1, s[40:43], s14 offen offset:3072 nt lds
  s_waitcnt vmcnt(6)
  s_add_u32 s14, s14, s15
  s_add_u32 m0, s13, 36864
  s_nop 0
  buffer_load_dwordx4 v1, s[40:43], s14 offen nt lds
  s_waitcnt vmcnt(6)
  buffer_load_dwordx4 v1, s[40:43], s14 offen offset:1024 nt lds
  s_waitcnt vmcnt(6)
  buffer_load_dwordx4 v1, s[40:43], s14 offen offset:2048 nt lds
  s_waitcnt vmcnt(6)
  buffer_load_dwordx4 v1, s[40:43], s14 offen offset:3072 nt lds
  s_barrier
  ds_read_b128 v[2:5], v46 offset:0
  s_waitcnt lgkmcnt(0)
  v_dot2_f32_bf16 v36, v64, v2, 0
  v_dot2_f32_bf16 v36, v65, v3, v36
  v_dot2_f32_bf16 v36, v66, v4, v36
  v_dot2_f32_bf16 v36, v67, v5, v36
  s_waitcnt vmcnt(6)
  s_add_u32 s14, s14, s15
  buffer_load_dwordx4 v[64:67], v1, s[40:43], s14 offen nt
  v_dot2_f32_bf16 v37, v68, v2, 0
  v_dot2_f32_bf16 v37, v69, v3, v37
  v_dot2_f32_bf16 v37, v70, v4, v37
  v_dot2_f32_bf16 v37, v71, v5, v37
  v_add_f32_dpp v38, v36, v36 row_ror:8 row_mask:0xf bank_mask:0x3
  s_nop 1
  v_add_f32_dpp v38, v37, v37 row_ror:8 row_mask:0xf bank_mask:0xc
  s_waitcnt vmcnt(6)
  buffer_load_dwordx4 v[68:71], v1, s[40:43], s14 offen offset:1024 nt
  v_dot2_f32_bf16 v36, v72, v2, 0
  v_dot2_f32_bf16 v36, v73, v3, v36
  v_dot2_f32_bf16 v36, v74, v4, v36
  v_dot2_f32_bf16 v36, v75, v5, v36
  s_waitcnt vmcnt(6)
  buffer_load_dwordx4 v[72:75], v1, s[40:43], s14 offen offset:2048 nt
  v_dot2_f32_bf16 v37, v76, v2, 0
  v_dot2_f32_bf16 v37, v77, v3, v37
  v_dot2_f32_bf16 v37, v78, v4, v37
  v_dot2_f32_bf16 v37, v79, v5, v37
  v_add_f32_dpp v39, v36, v36 row_ror:8 row_mask:0xf bank_mask:0x3
  s_nop 1
  v_add_f32_dpp v39, v37, v37 row_ror:8 row_mask:0xf bank_mask:0xc
  v_add_f32_dpp v40, v38, v38 row_shl:4 row_mask:0xf bank_mask:0x5
  s_nop 0
  v_add_f32_dpp v40, v39, v39 row_shr:4 row_mask:0xf bank_mask:0xa
  s_waitcnt vmcnt(6)
  buffer_load_dwordx4 v[76:79], v1, s[40:43], s14 offen offset:3072 nt
  v_dot2_f32_bf16 v36, v80, v2, 0
  v_dot2_f32_bf16 v36, v81, v3, v36
  v_dot2_f32_bf16 v36, v82, v4, v36
  v_dot2_f32_bf16 v36, v83, v5, v36
  s_waitcnt vmcnt(6)
  s_add_u32 s14, s14, s15
  buffer_load_dwordx4 v[80:83], v1, s[40:43], s14 offen nt
  v_dot2_f32_bf16 v37, v84, v2, 0
  v_dot2_f32_bf16 v37, v85, v3, v37
  v_dot2_f32_bf16 v37, v86, v4, v37
  v_dot2_f32_bf16 v37, v87, v5, v37
  v_add_f32_dpp v38, v36, v36 row_ror:8 row_mask:0xf bank_mask:0x3
  s_nop 1
  v_add_f32_dpp v38, v37, v37 row_ror:8 row_mask:0xf bank_mask:0xc
  s_waitcnt vmcnt(6)
  buffer_load_dwordx4 v[84:87], v1, s[40:43], s14 offen offset:1024 nt
  v_dot2_f32_bf16 v36, v88, v2, 0
  v_dot2_f32_bf16 v36, v89, v3, v36
  v_dot2_f32_bf16 v36, v90, v4, v36
  v_dot2_f32_bf16 v36, v91, v5, v36
  s_waitcnt vmcnt(6)
  buffer_load_dwordx4 v[88:91], v1, s[40:43], s14 offen offset:2048 nt
  v_dot2_f32_bf16 v37, v92, v2, 0
  v_dot2_f32_bf16 v37, v93, v3, v37
  v_dot2_f32_bf16 v37, v94, v4, v37
  v_dot2_f32_bf16 v37, v95, v5, v37
  v_add_f32_dpp v39, v36, v36 row_ror:8 row_mask:0xf bank_mask:0x3
  s_nop 1
  v_add_f32_dpp v39, v37, v37 row_ror:8 row_mask:0xf bank_mask:0xc
  v_add_f32_dpp v41, v38, v38 row_shl:4 row_mask:0xf bank_mask:0x5
  s_nop 0
  v_add_f32_dpp v41, v39, v39 row_shr:4 row_mask:0xf bank_mask:0xa
  v_cndmask_b32 v44, v40, v41, s[64:65]
  v_cndmask_b32 v45, v41, v40, s[64:65]
  s_nop 1
  v_add_f32_dpp v42, v45, v44 quad_perm:[1,0,3,2] row_mask:0xf bank_mask:0xf
  v_dot2_f32_bf16 v36, v96, v2, 0
  v_dot2_f32_bf16 v36, v97, v3, v36
  v_dot2_f32_bf16 v36, v98, v4, v36
  v_dot2_f32_bf16 v36, v99, v5, v36
  v_dot2_f32_bf16 v37, v100, v2, 0
  v_dot2_f32_bf16 v37, v101, v3, v37
  v_dot2_f32_bf16 v37, v102, v4, v37
  v_dot2_f32_bf16 v37, v103, v5, v37
  v_add_f32_dpp v38, v36, v36 row_ror:8 row_mask:0xf bank_mask:0x3
  s_nop 1
  v_add_f32_dpp v38, v37, v37 row_ror:8 row_mask:0xf bank_mask:0xc
  s_waitcnt vmcnt(6)
  buffer_load_dwordx4 v[92:95], v1, s[40:43], s14 offen offset:3072 nt
  v_dot2_f32_bf16 v36, v104, v2, 0
  v_dot2_f32_bf16 v36, v105, v3, v36
  v_dot2_f32_bf16 v36, v106, v4, v36
  v_dot2_f32_bf16 v36, v107, v5, v36
  v_dot2_f32_bf16 v37, v108, v2, 0
  v_dot2_f32_bf16 v37, v109, v3, v37
  v_dot2_f32_bf16 v37, v110, v4, v37
  v_dot2_f32_bf16 v37, v111, v5, v37
  v_add_f32_dpp v39, v36, v36 row_ror:8 row_mask:0xf bank_mask:0x3
  s_nop 1
  v_add_f32_dpp v39, v37, v37 row_ror:8 row_mask:0xf bank_mask:0xc
  v_add_f32_dpp v40, v38, v38 row_shl:4 row_mask:0xf bank_mask:0x5
  s_nop 0
  v_add_f32_dpp v40, v39, v39 row_shr:4 row_mask:0xf bank_mask:0xa
  v_dot2_f32_bf16 v36, v112, v2, 0
  v_dot2_f32_bf16 v36, v113, v3, v36
  v_dot2_f32_bf16 v36, v114, v4, v36
  v_dot2_f32_bf16 v36, v115, v5, v36
  s_waitcnt vmcnt(6)
  s_add_u32 s14, s14, s15
  buffer_load_dwordx4 v[96:99], v1, s[40:43], s14 offen nt
  v_dot2_f32_bf16 v37, v116, v2, 0
  v_dot2_f32_bf16 v37, v117, v3, v37
  v_dot2_f32_bf16 v37, v118, v4, v37
  v_dot2_f32_bf16 v37, v119, v5, v37
  v_add_f32_dpp v38, v36, v36 row_ror:8 row_mask:0xf bank_mask:0x3
  s_nop 1
  v_add_f32_dpp v38, v37, v37 row_ror:8 row_mask:0xf bank_mask:0xc
  v_dot2_f32_bf16 v36, v120, v2, 0
  v_dot2_f32_bf16 v36, v121, v3, v36
  v_dot2_f32_bf16 v36, v122, v4, v36
  v_dot2_f32_bf16 v36, v123, v5, v36
  v_dot2_f32_bf16 v37, v124, v2, 0
  v_dot2_f32_bf16 v37, v125, v3, v37
  v_dot2_f32_bf16 v37, v126, v4, v37
  v_dot2_f32_bf16 v37, v127, v5, v37
  v_add_f32_dpp v39, v36, v36 row_ror:8 row_mask:0xf bank_mask:0x3
  s_nop 1
  v_add_f32_dpp v39, v37, v37 row_ror:8 row_mask:0xf bank_mask:0xc
  v_add_f32_dpp v41, v38, v38 row_shl:4 row_mask:0xf bank_mask:0x5
  s_nop 0
  v_add_f32_dpp v41, v39, v39 row_shr:4 row_mask:0xf bank_mask:0xa
  v_cndmask_b32 v44, v40, v41, s[64:65]
  v_cndmask_b32 v45, v41, v40, s[64:65]
  s_nop 1
  v_add_f32_dpp v43, v45, v44 quad_perm:[1,0,3,2] row_mask:0xf bank_mask:0xf
  v_cndmask_b32 v44, v42, v43, s[66:67]
  v_cndmask_b32 v45, v43, v42, s[66:67]
  s_nop 1
  v_add_f32_dpp v10, v45, v44 quad_perm:[2,3,0,1] row_mask:0xf bank_mask:0xf
  v_cvt_pk_bf16_f32 v10, v10, v10
  v_and_b32 v10, 0xffff0000, v10
  v_mul_f32 v10, s68, v10
  v_cvt_pk_bf16_f32 v10, v10, v10
  v_and_b32 v10, 0xffff0000, v10
  s_waitcnt vmcnt(6)
  buffer_load_dwordx4 v[100:103], v1, s[40:43], s14 offen offset:1024 nt
  v_dot2_f32_bf16 v36, v128, v2, 0
  v_dot2_f32_bf16 v36, v129, v3, v36
  v_dot2_f32_bf16 v36, v130, v4, v36
  v_dot2_f32_bf16 v36, v131, v5, v36
  v_dot2_f32_bf16 v37, v132, v2, 0
  v_dot2_f32_bf16 v37, v133, v3, v37
  v_dot2_f32_bf16 v37, v134, v4, v37
  v_dot2_f32_bf16 v37, v135, v5, v37
  v_add_f32_dpp v38, v36, v36 row_ror:8 row_mask:0xf bank_mask:0x3
  s_nop 1
  v_add_f32_dpp v38, v37, v37 row_ror:8 row_mask:0xf bank_mask:0xc
  v_dot2_f32_bf16 v36, v136, v2, 0
  v_dot2_f32_bf16 v36, v137, v3, v36
  v_dot2_f32_bf16 v36, v138, v4, v36
  v_dot2_f32_bf16 v36, v139, v5, v36
  s_waitcnt vmcnt(6)
  buffer_load_dwordx4 v[104:107], v1, s[40:43], s14 offen offset:2048 nt
  v_dot2_f32_bf16 v37, v140, v2, 0
  v_dot2_f32_bf16 v37, v141, v3, v37
  v_dot2_f32_bf16 v37, v142, v4, v37
  v_dot2_f32_bf16 v37, v143, v5, v37
  v_add_f32_dpp v39, v36, v36 row_ror:8 row_mask:0xf bank_mask:0x3
  s_nop 1
  v_add_f32_dpp v39, v37, v37 row_ror:8 row_mask:0xf bank_mask:0xc
  v_add_f32_dpp v40, v38, v38 row_shl:4 row_mask:0xf bank_mask:0x5
  s_nop 0
  v_add_f32_dpp v40, v39, v39 row_shr:4 row_mask:0xf bank_mask:0xa
  v_dot2_f32_bf16 v36, v144, v2, 0
  v_dot2_f32_bf16 v36, v145, v3, v36
  v_dot2_f32_bf16 v36, v146, v4, v36
  v_dot2_f32_bf16 v36, v147, v5, v36
  v_dot2_f32_bf16 v37, v148, v2, 0
  v_dot2_f32_bf16 v37, v149, v3, v37
  v_dot2_f32_bf16 v37, v150, v4, v37
  v_dot2_f32_bf16 v37, v151, v5, v37
  v_add_f32_dpp v38, v36, v36 row_ror:8 row_mask:0xf bank_mask:0x3
  s_nop 1
  v_add_f32_dpp v38, v37, v37 row_ror:8 row_mask:0xf bank_mask:0xc
  s_waitcnt vmcnt(6)
  buffer_load_dwordx4 v[108:111], v1, s[40:43], s14 offen offset:3072 nt
  v_dot2_f32_bf16 v36, v152, v2, 0
  v_dot2_f32_bf16 v36, v153, v3, v36
  v_dot2_f32_bf16 v36, v154, v4, v36
  v_dot2_f32_bf16 v36, v155, v5, v36
  v_dot2_f32_bf16 v37, v156, v2, 0
  v_dot2_f32_bf16 v37, v157, v3, v37
  v_dot2_f32_bf16 v37, v158, v4, v37
  v_dot2_f32_bf16 v37, v159, v5, v37
  v_add_f32_dpp v39, v36, v36 row_ror:8 row_mask:0xf bank_mask:0x3
  s_nop 1
  v_add_f32_dpp v39, v37, v37 row_ror:8 row_mask:0xf bank_mask:0xc
  v_add_f32_dpp v41, v38, v38 row_shl:4 row_mask:0xf bank_mask:0x5
  s_nop 0
  v_add_f32_dpp v41, v39, v39 row_shr:4 row_mask:0xf bank_mask:0xa
  v_cndmask_b32 v44, v40, v41, s[64:65]
  v_cndmask_b32 v45, v41, v40, s[64:65]
  s_nop 1
  v_add_f32_dpp v42, v45, v44 quad_perm:[1,0,3,2] row_mask:0xf bank_mask:0xf
  v_dot2_f32_bf16 v36, v160, v2, 0
  v_dot2_f32_bf16 v36, v161, v3, v36
  v_dot2_f32_bf16 v36, v162, v4, v36
  v_dot2_f32_bf16 v36, v163, v5, v36
  s_waitcnt vmcnt(6)
  s_add_u32 s14, s14, s15
  buffer_load_dwordx4 v[112:115], v1, s[40:43], s14 offen nt
  v_dot2_f32_bf16 v37, v164, v2, 0
  v_dot2_f32_bf16 v37, v165, v3, v37
  v_dot2_f32_bf16 v37, v166, v4, v37
  v_dot2_f32_bf16 v37, v167, v5, v37
  v_add_f32_dpp v38, v36, v36 row_ror:8 row_mask:0xf bank_mask:0x3
  s_nop 1
  v_add_f32_dpp v38, v37, v37 row_ror:8 row_mask:0xf bank_mask:0xc
  v_dot2_f32_bf16 v36, v168, v2, 0
  v_dot2_f32_bf16 v36, v169, v3, v36
  v_dot2_f32_bf16 v36, v170, v4, v36
  v_dot2_f32_bf16 v36, v171, v5, v36
  v_dot2_f32_bf16 v37, v172, v2, 0
  v_dot2_f32_bf16 v37, v173, v3, v37
  v_dot2_f32_bf16 v37, v174, v4, v37
  v_dot2_f32_bf16 v37, v175, v5, v37
  v_add_f32_dpp v39, v36, v36 row_ror:8 row_mask:0xf bank_mask:0x3
  s_nop 1
  v_add_f32_dpp v39, v37, v37 row_ror:8 row_mask:0xf bank_mask:0xc
  v_add_f32_dpp v40, v38, v38 row_shl:4 row_mask:0xf bank_mask:0x5
  s_nop 0
  v_add_f32_dpp v40, v39, v39 row_shr:4 row_mask:0xf bank_mask:0xa
  s_waitcnt vmcnt(6)
  buffer_load_dwordx4 v[116:119], v1, s[40:43], s14 offen offset:1024 nt
  v_dot2_f32_bf16 v36, v176, v2, 0
  v_dot2_f32_bf16 v36, v177, v3, v36
  v_dot2_f32_bf16 v36, v178, v4, v36
  v_dot2_f32_bf16 v36, v179, v5, v36
  v_dot2_f32_bf16 v37, v180, v2, 0
  v_dot2_f32_bf16 v37, v181, v3, v37
  v_dot2_f32_bf16 v37, v182, v4, v37
  v_dot2_f32_bf16 v37, v183, v5, v37
  v_add_f32_dpp v38, v36, v36 row_ror:8 row_mask:0xf bank_mask:0x3
  s_nop 1
  v_add_f32_dpp v38, v37, v37 row_ror:8 row_mask:0xf bank_mask:0xc
  v_dot2_f32_bf16 v36, v184, v2, 0
  v_dot2_f32_bf16 v36, v185, v3, v36
  v_dot2_f32_bf16 v36, v186, v4, v36
  v_dot2_f32_bf16 v36, v187, v5, v36
  s_waitcnt vmcnt(6)
  buffer_load_dwordx4 v[120:123], v1, s[40:43], s14 offen offset:2048 nt
  v_dot2_f32_bf16 v37, v188, v2, 0
  v_dot2_f32_bf16 v37, v189, v3, v37
  v_dot2_f32_bf16 v37, v190, v4, v37
  v_dot2_f32_bf16 v37, v191, v5, v37
  v_add_f32_dpp v39, v36, v36 row_ror:8 row_mask:0xf bank_mask:0x3
  s_nop 1
  v_add_f32_dpp v39, v37, v37 row_ror:8 row_mask:0xf bank_mask:0xc
  v_add_f32_dpp v41, v38, v38 row_shl:4 row_mask:0xf bank_mask:0x5
  s_nop 0
  v_add_f32_dpp v41, v39, v39 row_shr:4 row_mask:0xf bank_mask:0xa
  v_cndmask_b32 v44, v40, v41, s[64:65]
  v_cndmask_b32 v45, v41, v40, s[64:65]
  s_nop 1
  v_add_f32_dpp v43, v45, v44 quad_perm:[1,0,3,2] row_mask:0xf bank_mask:0xf
  v_cndmask_b32 v44, v42, v43, s[66:67]
  v_cndmask_b32 v45, v43, v42, s[66:67]
  s_nop 1
  v_add_f32_dpp v11, v45, v44 quad_perm:[2,3,0,1] row_mask:0xf bank_mask:0xf
  v_cvt_pk_bf16_f32 v11, v11, v11
  v_and_b32 v11, 0xffff0000, v11
  v_mul_f32 v11, s68, v11
  v_cvt_pk_bf16_f32 v11, v11, v11
  v_and_b32 v11, 0xffff0000, v11
  v_dot2_f32_bf16 v36, v192, v2, 0
  v_dot2_f32_bf16 v36, v193, v3, v36
  v_dot2_f32_bf16 v36, v194, v4, v36
  v_dot2_f32_bf16 v36, v195, v5, v36
  v_dot2_f32_bf16 v37, v196, v2, 0
  v_dot2_f32_bf16 v37, v197, v3, v37
  v_dot2_f32_bf16 v37, v198, v4, v37
  v_dot2_f32_bf16 v37, v199, v5, v37
  v_add_f32_dpp v38, v36, v36 row_ror:8 row_mask:0xf bank_mask:0x3
  s_nop 1
  v_add_f32_dpp v38, v37, v37 row_ror:8 row_mask:0xf bank_mask:0xc
  s_waitcnt vmcnt(6)
  buffer_load_dwordx4 v[124:127], v1, s[40:43], s14 offen offset:3072 nt
  v_dot2_f32_bf16 v36, v200, v2, 0
  v_dot2_f32_bf16 v36, v201, v3, v36
  v_dot2_f32_bf16 v36, v202, v4, v36
  v_dot2_f32_bf16 v36, v203, v5, v36
  v_dot2_f32_bf16 v37, v204, v2, 0
  v_dot2_f32_bf16 v37, v205, v3, v37
  v_dot2_f32_bf16 v37, v206, v4, v37
  v_dot2_f32_bf16 v37, v207, v5, v37
  v_add_f32_dpp v39, v36, v36 row_ror:8 row_mask:0xf bank_mask:0x3
  s_nop 1
  v_add_f32_dpp v39, v37, v37 row_ror:8 row_mask:0xf bank_mask:0xc
  v_add_f32_dpp v40, v38, v38 row_shl:4 row_mask:0xf bank_mask:0x5
  s_nop 0
  v_add_f32_dpp v40, v39, v39 row_shr:4 row_mask:0xf bank_mask:0xa
  v_dot2_f32_bf16 v36, v208, v2, 0
  v_dot2_f32_bf16 v36, v209, v3, v36
  v_dot2_f32_bf16 v36, v210, v4, v36
  v_dot2_f32_bf16 v36, v211, v5, v36
  s_waitcnt vmcnt(6)
  s_add_u32 s14, s14, s15
  buffer_load_dwordx4 v[128:131], v1, s[40:43], s14 offen nt
  v_dot2_f32_bf16 v37, v212, v2, 0
  v_dot2_f32_bf16 v37, v213, v3, v37
  v_dot2_f32_bf16 v37, v214, v4, v37
  v_dot2_f32_bf16 v37, v215, v5, v37
  v_add_f32_dpp v38, v36, v36 row_ror:8 row_mask:0xf bank_mask:0x3
  s_nop 1
  v_add_f32_dpp v38, v37, v37 row_ror:8 row_mask:0xf bank_mask:0xc
  v_dot2_f32_bf16 v36, v216, v2, 0
  v_dot2_f32_bf16 v36, v217, v3, v36
  v_dot2_f32_bf16 v36, v218, v4, v36
  v_dot2_f32_bf16 v36, v219, v5, v36
  v_dot2_f32_bf16 v37, v220, v2, 0
  v_dot2_f32_bf16 v37, v221, v3, v37
  v_dot2_f32_bf16 v37, v222, v4, v37
  v_dot2_f32_bf16 v37, v223, v5, v37
  v_add_f32_dpp v39, v36, v36 row_ror:8 row_mask:0xf bank_mask:0x3
  s_nop 1
  v_add_f32_dpp v39, v37, v37 row_ror:8 row_mask:0xf bank_mask:0xc
  v_add_f32_dpp v41, v38, v38 row_shl:4 row_mask:0xf bank_mask:0x5
  s_nop 0
  v_add_f32_dpp v41, v39, v39 row_shr:4 row_mask:0xf bank_mask:0xa
  v_cndmask_b32 v44, v40, v41, s[64:65]
  v_cndmask_b32 v45, v41, v40, s[64:65]
  s_nop 1
  v_add_f32_dpp v42, v45, v44 quad_perm:[1,0,3,2] row_mask:0xf bank_mask:0xf
  s_waitcnt vmcnt(6)
  buffer_load_dwordx4 v[132:135], v1, s[40:43], s14 offen offset:1024 nt
  v_dot2_f32_bf16 v36, v224, v2, 0
  v_dot2_f32_bf16 v36, v225, v3, v36
  v_dot2_f32_bf16 v36, v226, v4, v36
  v_dot2_f32_bf16 v36, v227, v5, v36
  v_dot2_f32_bf16 v37, v228, v2, 0
  v_dot2_f32_bf16 v37, v229, v3, v37
  v_dot2_f32_bf16 v37, v230, v4, v37
  v_dot2_f32_bf16 v37, v231, v5, v37
  v_add_f32_dpp v38, v36, v36 row_ror:8 row_mask:0xf bank_mask:0x3
  s_nop 1
  v_add_f32_dpp v38, v37, v37 row_ror:8 row_mask:0xf bank_mask:0xc
  v_dot2_f32_bf16 v36, v232, v2, 0
  v_dot2_f32_bf16 v36, v233, v3, v36
  v_dot2_f32_bf16 v36, v234, v4, v36
  v_dot2_f32_bf16 v36, v235, v5, v36
  s_waitcnt vmcnt(6)
  buffer_load_dwordx4 v[136:139], v1, s[40:43], s14 offen offset:2048 nt
  v_dot2_f32_bf16 v37, v236, v2, 0
  v_dot2_f32_bf16 v37, v237, v3, v37
  v_dot2_f32_bf16 v37, v238, v4, v37
  v_dot2_f32_bf16 v37, v239, v5, v37
  v_add_f32_dpp v39, v36, v36 row_ror:8 row_mask:0xf bank_mask:0x3
  s_nop 1
  v_add_f32_dpp v39, v37, v37 row_ror:8 row_mask:0xf bank_mask:0xc
  v_add_f32_dpp v40, v38, v38 row_shl:4 row_mask:0xf bank_mask:0x5
  s_nop 0
  v_add_f32_dpp v40, v39, v39 row_shr:4 row_mask:0xf bank_mask:0xa
  v_dot2_f32_bf16 v36, v240, v2, 0
  v_dot2_f32_bf16 v36, v241, v3, v36
  v_dot2_f32_bf16 v36, v242, v4, v36
  v_dot2_f32_bf16 v36, v243, v5, v36
  v_dot2_f32_bf16 v37, v244, v2, 0
  v_dot2_f32_bf16 v37, v245, v3, v37
  v_dot2_f32_bf16 v37, v246, v4, v37
  v_dot2_f32_bf16 v37, v247, v5, v37
  v_add_f32_dpp v38, v36, v36 row_ror:8 row_mask:0xf bank_mask:0x3
  s_nop 1
  v_add_f32_dpp v38, v37, v37 row_ror:8 row_mask:0xf bank_mask:0xc
  s_waitcnt vmcnt(6)
  buffer_load_dwordx4 v[140:143], v1, s[40:43], s14 offen offset:3072 nt
  v_dot2_f32_bf16 v36, v248, v2, 0
  v_dot2_f32_bf16 v36, v249, v3, v36
  v_dot2_f32_bf16 v36, v250, v4, v36
  v_dot2_f32_bf16 v36, v251, v5, v36
  ds_read_b128 v[52:55], v47 offset:8192
  v_dot2_f32_bf16 v37, v252, v2, 0
  v_dot2_f32_bf16 v37, v253, v3, v37
  v_dot2_f32_bf16 v37, v254, v4, v37
  v_dot2_f32_bf16 v37, v255, v5, v37
  v_add_f32_dpp v39, v36, v36 row_ror:8 row_mask:0xf bank_mask:0x3
  s_nop 1
  v_add_f32_dpp v39, v37, v37 row_ror:8 row_mask:0xf bank_mask:0xc
  v_add_f32_dpp v41, v38, v38 row_shl:4 row_mask:0xf bank_mask:0x5
  s_nop 0
  v_add_f32_dpp v41, v39, v39 row_shr:4 row_mask:0xf bank_mask:0xa
  v_cndmask_b32 v44, v40, v41, s[64:65]
  v_cndmask_b32 v45, v41, v40, s[64:65]
  s_nop 1
  v_add_f32_dpp v43, v45, v44 quad_perm:[1,0,3,2] row_mask:0xf bank_mask:0xf
  v_cndmask_b32 v44, v42, v43, s[66:67]
  v_cndmask_b32 v45, v43, v42, s[66:67]
  s_nop 1
  v_add_f32_dpp v12, v45, v44 quad_perm:[2,3,0,1] row_mask:0xf bank_mask:0xf
  v_cvt_pk_bf16_f32 v12, v12, v12
  v_and_b32 v12, 0xffff0000, v12
  v_mul_f32 v12, s68, v12
  v_cvt_pk_bf16_f32 v12, v12, v12
  v_and_b32 v12, 0xffff0000, v12
  ds_read_b128 v[56:59], v47 offset:9216
  s_waitcnt lgkmcnt(1)
  v_dot2_f32_bf16 v36, v52, v2, 0
  v_dot2_f32_bf16 v36, v53, v3, v36
  v_dot2_f32_bf16 v36, v54, v4, v36
  v_dot2_f32_bf16 v36, v55, v5, v36
  s_waitcnt vmcnt(6)
  s_add_u32 s14, s14, s15
  buffer_load_dwordx4 v[144:147], v1, s[40:43], s14 offen nt
  ds_read_b128 v[52:55], v47 offset:10240
  s_waitcnt lgkmcnt(1)
  v_dot2_f32_bf16 v37, v56, v2, 0
  v_dot2_f32_bf16 v37, v57, v3, v37
  v_dot2_f32_bf16 v37, v58, v4, v37
  v_dot2_f32_bf16 v37, v59, v5, v37
  v_add_f32_dpp v38, v36, v36 row_ror:8 row_mask:0xf bank_mask:0x3
  s_nop 1
  v_add_f32_dpp v38, v37, v37 row_ror:8 row_mask:0xf bank_mask:0xc
  ds_read_b128 v[56:59], v47 offset:11264
  s_waitcnt lgkmcnt(1)
  v_dot2_f32_bf16 v36, v52, v2, 0
  v_dot2_f32_bf16 v36, v53, v3, v36
  v_dot2_f32_bf16 v36, v54, v4, v36
  v_dot2_f32_bf16 v36, v55, v5, v36
  ds_read_b128 v[52:55], v47 offset:12288
  s_waitcnt lgkmcnt(1)
  v_dot2_f32_bf16 v37, v56, v2, 0
  v_dot2_f32_bf16 v37, v57, v3, v37
  v_dot2_f32_bf16 v37, v58, v4, v37
  v_dot2_f32_bf16 v37, v59, v5, v37
  v_add_f32_dpp v39, v36, v36 row_ror:8 row_mask:0xf bank_mask:0x3
  s_nop 1
  v_add_f32_dpp v39, v37, v37 row_ror:8 row_mask:0xf bank_mask:0xc
  v_add_f32_dpp v40, v38, v38 row_shl:4 row_mask:0xf bank_mask:0x5
  s_nop 0
  v_add_f32_dpp v40, v39, v39 row_shr:4 row_mask:0xf bank_mask:0xa
  s_waitcnt vmcnt(6)
  buffer_load_dwordx4 v[148:151], v1, s[40:43], s14 offen offset:1024 nt
  ds_read_b128 v[56:59], v47 offset:13312
  s_waitcnt lgkmcnt(1)
  v_dot2_f32_bf16 v36, v52, v2, 0
  v_dot2_f32_bf16 v36, v53, v3, v36
  v_dot2_f32_bf16 v36, v54, v4, v36
  v_dot2_f32_bf16 v36, v55, v5, v36
  ds_read_b128 v[52:55], v47 offset:14336
  s_waitcnt lgkmcnt(1)
  v_dot2_f32_bf16 v37, v56, v2, 0
  v_dot2_f32_bf16 v37, v57, v3, v37
  v_dot2_f32_bf16 v37, v58, v4, v37
  v_dot2_f32_bf16 v37, v59, v5, v37
  v_add_f32_dpp v38, v36, v36 row_ror:8 row_mask:0xf bank_mask:0x3
  s_nop 1
  v_add_f32_dpp v38, v37, v37 row_ror:8 row_mask:0xf bank_mask:0xc
  ds_read_b128 v[56:59], v47 offset:15360
  s_waitcnt lgkmcnt(1)
  v_dot2_f32_bf16 v36, v52, v2, 0
  v_dot2_f32_bf16 v36, v53, v3, v36
  v_dot2_f32_bf16 v36, v54, v4, v36
  v_dot2_f32_bf16 v36, v55, v5, v36
  s_waitcnt vmcnt(6)
  buffer_load_dwordx4 v[152:155], v1, s[40:43], s14 offen offset:2048 nt
  ds_read_b128 v[52:55], v47 offset:16384
  s_waitcnt lgkmcnt(1)
  v_dot2_f32_bf16 v37, v56, v2, 0
  v_dot2_f32_bf16 v37, v57, v3, v37
  v_dot2_f32_bf16 v37, v58, v4, v37
  v_dot2_f32_bf16 v37, v59, v5, v37
  v_add_f32_dpp v39, v36, v36 row_ror:8 row_mask:0xf bank_mask:0x3
  s_nop 1
  v_add_f32_dpp v39, v37, v37 row_ror:8 row_mask:0xf bank_mask:0xc
  v_add_f32_dpp v41, v38, v38 row_shl:4 row_mask:0xf bank_mask:0x5
  s_nop 0
  v_add_f32_dpp v41, v39, v39 row_shr:4 row_mask:0xf bank_mask:0xa
  v_cndmask_b32 v44, v40, v41, s[64:65]
  v_cndmask_b32 v45, v41, v40, s[64:65]
  s_nop 1
  v_add_f32_dpp v42, v45, v44 quad_perm:[1,0,3,2] row_mask:0xf bank_mask:0xf
  ds_read_b128 v[56:59], v47 offset:17408
  s_waitcnt lgkmcnt(1)
  v_dot2_f32_bf16 v36, v52, v2, 0
  v_dot2_f32_bf16 v36, v53, v3, v36
  v_dot2_f32_bf16 v36, v54, v4, v36
  v_dot2_f32_bf16 v36, v55, v5, v36
  ds_read_b128 v[52:55], v47 offset:18432
  s_waitcnt lgkmcnt(1)
  v_dot2_f32_bf16 v37, v56, v2, 0
  v_dot2_f32_bf16 v37, v57, v3, v37
  v_dot2_f32_bf16 v37, v58, v4, v37
  v_dot2_f32_bf16 v37, v59, v5, v37
  v_add_f32_dpp v38, v36, v36 row_ror:8 row_mask:0xf bank_mask:0x3
  s_nop 1
  v_add_f32_dpp v38, v37, v37 row_ror:8 row_mask:0xf bank_mask:0xc
  s_waitcnt vmcnt(6)
  buffer_load_dwordx4 v[156:159], v1, s[40:43], s14 offen offset:3072 nt
  ds_read_b128 v[56:59], v47 offset:19456
  s_waitcnt lgkmcnt(1)
  v_dot2_f32_bf16 v36, v52, v2, 0
  v_dot2_f32_bf16 v36, v53, v3, v36
  v_dot2_f32_bf16 v36, v54, v4, v36
  v_dot2_f32_bf16 v36, v55, v5, v36
  ds_read_b128 v[52:55], v47 offset:20480
  s_waitcnt lgkmcnt(1)
  v_dot2_f32_bf16 v37, v56, v2, 0
  v_dot2_f32_bf16 v37, v57, v3, v37
  v_dot2_f32_bf16 v37, v58, v4, v37
  v_dot2_f32_bf16 v37, v59, v5, v37
  v_add_f32_dpp v39, v36, v36 row_ror:8 row_mask:0xf bank_mask:0x3
  s_nop 1
  v_add_f32_dpp v39, v37, v37 row_ror:8 row_mask:0xf bank_mask:0xc
  v_add_f32_dpp v40, v38, v38 row_shl:4 row_mask:0xf bank_mask:0x5
  s_nop 0
  v_add_f32_dpp v40, v39, v39 row_shr:4 row_mask:0xf bank_mask:0xa
  ds_read_b128 v[56:59], v47 offset:21504
  s_waitcnt lgkmcnt(1)
  v_dot2_f32_bf16 v36, v52, v2, 0
  v_dot2_f32_bf16 v36, v53, v3, v36
  v_dot2_f32_bf16 v36, v54, v4, v36
  v_dot2_f32_bf16 v36, v55, v5, v36
  s_waitcnt vmcnt(6)
  s_add_u32 s14, s14, s15
  buffer_load_dwordx4 v[160:163], v1, s[40:43], s14 offen nt
  ds_read_b128 v[52:55], v47 offset:22528
  s_waitcnt lgkmcnt(1)
  v_dot2_f32_bf16 v37, v56, v2, 0
  v_dot2_f32_bf16 v37, v57, v3, v37
  v_dot2_f32_bf16 v37, v58, v4, v37
  v_dot2_f32_bf16 v37, v59, v5, v37
  v_add_f32_dpp v38, v36, v36 row_ror:8 row_mask:0xf bank_mask:0x3
  s_nop 1
  v_add_f32_dpp v38, v37, v37 row_ror:8 row_mask:0xf bank_mask:0xc
  ds_read_b128 v[56:59], v47 offset:23552
  s_waitcnt lgkmcnt(1)
  v_dot2_f32_bf16 v36, v52, v2, 0
  v_dot2_f32_bf16 v36, v53, v3, v36
  v_dot2_f32_bf16 v36, v54, v4, v36
  v_dot2_f32_bf16 v36, v55, v5, v36
  ds_read_b128 v[52:55], v47 offset:24576
  s_waitcnt lgkmcnt(1)
  v_dot2_f32_bf16 v37, v56, v2, 0
  v_dot2_f32_bf16 v37, v57, v3, v37
  v_dot2_f32_bf16 v37, v58, v4, v37
  v_dot2_f32_bf16 v37, v59, v5, v37
  v_add_f32_dpp v39, v36, v36 row_ror:8 row_mask:0xf bank_mask:0x3
  s_nop 1
  v_add_f32_dpp v39, v37, v37 row_ror:8 row_mask:0xf bank_mask:0xc
  v_add_f32_dpp v41, v38, v38 row_shl:4 row_mask:0xf bank_mask:0x5
  s_nop 0
  v_add_f32_dpp v41, v39, v39 row_shr:4 row_mask:0xf bank_mask:0xa
  v_cndmask_b32 v44, v40, v41, s[64:65]
  v_cndmask_b32 v45, v41, v40, s[64:65]
  s_nop 1
  v_add_f32_dpp v43, v45, v44 quad_perm:[1,0,3,2] row_mask:0xf bank_mask:0xf
  v_cndmask_b32 v44, v42, v43, s[66:67]
  v_cndmask_b32 v45, v43, v42, s[66:67]
  s_nop 1
  v_add_f32_dpp v13, v45, v44 quad_perm:[2,3,0,1] row_mask:0xf bank_mask:0xf
  v_cvt_pk_bf16_f32 v13, v13, v13
  v_and_b32 v13, 0xffff0000, v13
  v_mul_f32 v13, s68, v13
  v_cvt_pk_bf16_f32 v13, v13, v13
  v_and_b32 v13, 0xffff0000, v13
  s_waitcnt vmcnt(6)
  buffer_load_dwordx4 v[164:167], v1, s[40:43], s14 offen offset:1024 nt
  ds_read_b128 v[56:59], v47 offset:25600
  s_waitcnt lgkmcnt(1)
  v_dot2_f32_bf16 v36, v52, v2, 0
  v_dot2_f32_bf16 v36, v53, v3, v36
  v_dot2_f32_bf16 v36, v54, v4, v36
  v_dot2_f32_bf16 v36, v55, v5, v36
  ds_read_b128 v[52:55], v47 offset:26624
  s_waitcnt lgkmcnt(1)
  v_dot2_f32_bf16 v37, v56, v2, 0
  v_dot2_f32_bf16 v37, v57, v3, v37
  v_dot2_f32_bf16 v37, v58, v4, v37
  v_dot2_f32_bf16 v37, v59, v5, v37
  v_add_f32_dpp v38, v36, v36 row_ror:8 row_mask:0xf bank_mask:0x3
  s_nop 1
  v_add_f32_dpp v38, v37, v37 row_ror:8 row_mask:0xf bank_mask:0xc
  ds_read_b128 v[56:59], v47 offset:27648
  s_waitcnt lgkmcnt(1)
  v_dot2_f32_bf16 v36, v52, v2, 0
  v_dot2_f32_bf16 v36, v53, v3, v36
  v_dot2_f32_bf16 v36, v54, v4, v36
  v_dot2_f32_bf16 v36, v55, v5, v36
  s_waitcnt vmcnt(6)
  buffer_load_dwordx4 v[168:171], v1, s[40:43], s14 offen offset:2048 nt
  ds_read_b128 v[52:55], v47 offset:28672
  s_waitcnt lgkmcnt(1)
  v_dot2_f32_bf16 v37, v56, v2, 0
  v_dot2_f32_bf16 v37, v57, v3, v37
  v_dot2_f32_bf16 v37, v58, v4, v37
  v_dot2_f32_bf16 v37, v59, v5, v37
  v_add_f32_dpp v39, v36, v36 row_ror:8 row_mask:0xf bank_mask:0x3
  s_nop 1
  v_add_f32_dpp v39, v37, v37 row_ror:8 row_mask:0xf bank_mask:0xc
  v_add_f32_dpp v40, v38, v38 row_shl:4 row_mask:0xf bank_mask:0x5
  s_nop 0
  v_add_f32_dpp v40, v39, v39 row_shr:4 row_mask:0xf bank_mask:0xa
  ds_read_b128 v[56:59], v47 offset:29696
  s_waitcnt lgkmcnt(1)
  v_dot2_f32_bf16 v36, v52, v2, 0
  v_dot2_f32_bf16 v36, v53, v3, v36
  v_dot2_f32_bf16 v36, v54, v4, v36
  v_dot2_f32_bf16 v36, v55, v5, v36
  ds_read_b128 v[52:55], v47 offset:30720
  s_waitcnt lgkmcnt(1)
  v_dot2_f32_bf16 v37, v56, v2, 0
  v_dot2_f32_bf16 v37, v57, v3, v37
  v_dot2_f32_bf16 v37, v58, v4, v37
  v_dot2_f32_bf16 v37, v59, v5, v37
  v_add_f32_dpp v38, v36, v36 row_ror:8 row_mask:0xf bank_mask:0x3
  s_nop 1
  v_add_f32_dpp v38, v37, v37 row_ror:8 row_mask:0xf bank_mask:0xc
  s_waitcnt vmcnt(6)
  buffer_load_dwordx4 v[172:175], v1, s[40:43], s14 offen offset:3072 nt
  ds_read_b128 v[56:59], v47 offset:31744
  s_waitcnt lgkmcnt(1)
  v_dot2_f32_bf16 v36, v52, v2, 0
  v_dot2_f32_bf16 v36, v53, v3, v36
  v_dot2_f32_bf16 v36, v54, v4, v36
  v_dot2_f32_bf16 v36, v55, v5, v36
  ds_read_b128 v[52:55], v47 offset:32768
  s_waitcnt lgkmcnt(1)
  v_dot2_f32_bf16 v37, v56, v2, 0
  v_dot2_f32_bf16 v37, v57, v3, v37
  v_dot2_f32_bf16 v37, v58, v4, v37
  v_dot2_f32_bf16 v37, v59, v5, v37
  v_add_f32_dpp v39, v36, v36 row_ror:8 row_mask:0xf bank_mask:0x3
  s_nop 1
  v_add_f32_dpp v39, v37, v37 row_ror:8 row_mask:0xf bank_mask:0xc
  v_add_f32_dpp v41, v38, v38 row_shl:4 row_mask:0xf bank_mask:0x5
  s_nop 0
  v_add_f32_dpp v41, v39, v39 row_shr:4 row_mask:0xf bank_mask:0xa
  v_cndmask_b32 v44, v40, v41, s[64:65]
  v_cndmask_b32 v45, v41, v40, s[64:65]
  s_nop 1
  v_add_f32_dpp v42, v45, v44 quad_perm:[1,0,3,2] row_mask:0xf bank_mask:0xf
  ds_read_b128 v[56:59], v47 offset:33792
  s_waitcnt lgkmcnt(1)
  v_dot2_f32_bf16 v36, v52, v2, 0
  v_dot2_f32_bf16 v36, v53, v3, v36
  v_dot2_f32_bf16 v36, v54, v4, v36
  v_dot2_f32_bf16 v36, v55, v5, v36
  s_waitcnt vmcnt(6)
  s_add_u32 s14, s14, s15
  buffer_load_dwordx4 v[176:179], v1, s[40:43], s14 offen nt
  ds_read_b128 v[52:55], v47 offset:34816
  s_waitcnt lgkmcnt(1)
  v_dot2_f32_bf16 v37, v56, v2, 0
  v_dot2_f32_bf16 v37, v57, v3, v37
  v_dot2_f32_bf16 v37, v58, v4, v37
  v_dot2_f32_bf16 v37, v59, v5, v37
  v_add_f32_dpp v38, v36, v36 row_ror:8 row_mask:0xf bank_mask:0x3
  s_nop 1
  v_add_f32_dpp v38, v37, v37 row_ror:8 row_mask:0xf bank_mask:0xc
  ds_read_b128 v[56:59], v47 offset:35840
  s_waitcnt lgkmcnt(1)
  v_dot2_f32_bf16 v36, v52, v2, 0
  v_dot2_f32_bf16 v36, v53, v3, v36
  v_dot2_f32_bf16 v36, v54, v4, v36
  v_dot2_f32_bf16 v36, v55, v5, v36
  ds_read_b128 v[52:55], v47 offset:36864
  s_waitcnt lgkmcnt(1)
  v_dot2_f32_bf16 v37, v56, v2, 0
  v_dot2_f32_bf16 v37, v57, v3, v37
  v_dot2_f32_bf16 v37, v58, v4, v37
  v_dot2_f32_bf16 v37, v59, v5, v37
  v_add_f32_dpp v39, v36, v36 row_ror:8 row_mask:0xf bank_mask:0x3
  s_nop 1
  v_add_f32_dpp v39, v37, v37 row_ror:8 row_mask:0xf bank_mask:0xc
  v_add_f32_dpp v40, v38, v38 row_shl:4 row_mask:0xf bank_mask:0x5
  s_nop 0
  v_add_f32_dpp v40, v39, v39 row_shr:4 row_mask:0xf bank_mask:0xa
  s_waitcnt vmcnt(6)
  buffer_load_dwordx4 v[180:183], v1, s[40:43], s14 offen offset:1024 nt
  ds_read_b128 v[56:59], v47 offset:37888
  s_waitcnt lgkmcnt(1)
  v_dot2_f32_bf16 v36, v52, v2, 0
  v_dot2_f32_bf16 v36, v53, v3, v36
  v_dot2_f32_bf16 v36, v54, v4, v36
  v_dot2_f32_bf16 v36, v55, v5, v36
  ds_read_b128 v[52:55], v47 offset:38912
  s_waitcnt lgkmcnt(1)
  v_dot2_f32_bf16 v37, v56, v2, 0
  v_dot2_f32_bf16 v37, v57, v3, v37
  v_dot2_f32_bf16 v37, v58, v4, v37
  v_dot2_f32_bf16 v37, v59, v5, v37
  v_add_f32_dpp v38, v36, v36 row_ror:8 row_mask:0xf bank_mask:0x3
  s_nop 1
  v_add_f32_dpp v38, v37, v37 row_ror:8 row_mask:0xf bank_mask:0xc
  ds_read_b128 v[56:59], v47 offset:39936
  s_waitcnt lgkmcnt(1)
  v_dot2_f32_bf16 v36, v52, v2, 0
  v_dot2_f32_bf16 v36, v53, v3, v36
  v_dot2_f32_bf16 v36, v54, v4, v36
  v_dot2_f32_bf16 v36, v55, v5, v36
  s_waitcnt vmcnt(6)
  buffer_load_dwordx4 v[184:187], v1, s[40:43], s14 offen offset:2048 nt
  s_waitcnt lgkmcnt(0)
  v_dot2_f32_bf16 v37, v56, v2, 0
  v_dot2_f32_bf16 v37, v57, v3, v37
  v_dot2_f32_bf16 v37, v58, v4, v37
  v_dot2_f32_bf16 v37, v59, v5, v37
  v_add_f32_dpp v39, v36, v36 row_ror:8 row_mask:0xf bank_mask:0x3
  s_nop 1
  v_add_f32_dpp v39, v37, v37 row_ror:8 row_mask:0xf bank_mask:0xc
  v_add_f32_dpp v41, v38, v38 row_shl:4 row_mask:0xf bank_mask:0x5
  s_nop 0
  v_add_f32_dpp v41, v39, v39 row_shr:4 row_mask:0xf bank_mask:0xa
  v_cndmask_b32 v44, v40, v41, s[64:65]
  v_cndmask_b32 v45, v41, v40, s[64:65]
  s_nop 1
  v_add_f32_dpp v43, v45, v44 quad_perm:[1,0,3,2] row_mask:0xf bank_mask:0xf
  v_cndmask_b32 v44, v42, v43, s[66:67]
  v_cndmask_b32 v45, v43, v42, s[66:67]
  s_nop 1
  v_add_f32_dpp v14, v45, v44 quad_perm:[2,3,0,1] row_mask:0xf bank_mask:0xf
  v_cvt_pk_bf16_f32 v14, v14, v14
  v_and_b32 v14, 0xffff0000, v14
  v_mul_f32 v14, s68, v14
  v_cvt_pk_bf16_f32 v14, v14, v14
  v_and_b32 v14, 0xffff0000, v14
  v_dot2_f32_bf16 v36, v64, v2, 0
  v_dot2_f32_bf16 v36, v65, v3, v36
  v_dot2_f32_bf16 v36, v66, v4, v36
  v_dot2_f32_bf16 v36, v67, v5, v36
  v_dot2_f32_bf16 v37, v68, v2, 0
  v_dot2_f32_bf16 v37, v69, v3, v37
  v_dot2_f32_bf16 v37, v70, v4, v37
  v_dot2_f32_bf16 v37, v71, v5, v37
  v_add_f32_dpp v38, v36, v36 row_ror:8 row_mask:0xf bank_mask:0x3
  s_nop 1
  v_add_f32_dpp v38, v37, v37 row_ror:8 row_mask:0xf bank_mask:0xc
  s_waitcnt vmcnt(6)
  buffer_load_dwordx4 v[188:191], v1, s[40:43], s14 offen offset:3072 nt
  v_dot2_f32_bf16 v36, v72, v2, 0
  v_dot2_f32_bf16 v36, v73, v3, v36
  v_dot2_f32_bf16 v36, v74, v4, v36
  v_dot2_f32_bf16 v36, v75, v5, v36
  v_dot2_f32_bf16 v37, v76, v2, 0
  v_dot2_f32_bf16 v37, v77, v3, v37
  v_dot2_f32_bf16 v37, v78, v4, v37
  v_dot2_f32_bf16 v37, v79, v5, v37
  v_add_f32_dpp v39, v36, v36 row_ror:8 row_mask:0xf bank_mask:0x3
  s_nop 1
  v_add_f32_dpp v39, v37, v37 row_ror:8 row_mask:0xf bank_mask:0xc
  v_add_f32_dpp v40, v38, v38 row_shl:4 row_mask:0xf bank_mask:0x5
  s_nop 0
  v_add_f32_dpp v40, v39, v39 row_shr:4 row_mask:0xf bank_mask:0xa
  v_dot2_f32_bf16 v36, v80, v2, 0
  v_dot2_f32_bf16 v36, v81, v3, v36
  v_dot2_f32_bf16 v36, v82, v4, v36
  v_dot2_f32_bf16 v36, v83, v5, v36
  s_waitcnt vmcnt(6)
  s_add_u32 s14, s14, s15
  buffer_load_dwordx4 v[192:195], v1, s[40:43], s14 offen nt
  v_dot2_f32_bf16 v37, v84, v2, 0
  v_dot2_f32_bf16 v37, v85, v3, v37
  v_dot2_f32_bf16 v37, v86, v4, v37
  v_dot2_f32_bf16 v37, v87, v5, v37
  v_add_f32_dpp v38, v36, v36 row_ror:8 row_mask:0xf bank_mask:0x3
  s_nop 1
  v_add_f32_dpp v38, v37, v37 row_ror:8 row_mask:0xf bank_mask:0xc
  v_dot2_f32_bf16 v36, v88, v2, 0
  v_dot2_f32_bf16 v36, v89, v3, v36
  v_dot2_f32_bf16 v36, v90, v4, v36
  v_dot2_f32_bf16 v36, v91, v5, v36
  v_dot2_f32_bf16 v37, v92, v2, 0
  v_dot2_f32_bf16 v37, v93, v3, v37
  v_dot2_f32_bf16 v37, v94, v4, v37
  v_dot2_f32_bf16 v37, v95, v5, v37
  v_add_f32_dpp v39, v36, v36 row_ror:8 row_mask:0xf bank_mask:0x3
  s_nop 1
  v_add_f32_dpp v39, v37, v37 row_ror:8 row_mask:0xf bank_mask:0xc
  v_add_f32_dpp v41, v38, v38 row_shl:4 row_mask:0xf bank_mask:0x5
  s_nop 0
  v_add_f32_dpp v41, v39, v39 row_shr:4 row_mask:0xf bank_mask:0xa
  v_cndmask_b32 v44, v40, v41, s[64:65]
  v_cndmask_b32 v45, v41, v40, s[64:65]
  s_nop 1
  v_add_f32_dpp v42, v45, v44 quad_perm:[1,0,3,2] row_mask:0xf bank_mask:0xf
  s_waitcnt vmcnt(6)
  buffer_load_dwordx4 v[196:199], v1, s[40:43], s14 offen offset:1024 nt
  v_dot2_f32_bf16 v36, v96, v2, 0
  v_dot2_f32_bf16 v36, v97, v3, v36
  v_dot2_f32_bf16 v36, v98, v4, v36
  v_dot2_f32_bf16 v36, v99, v5, v36
  v_dot2_f32_bf16 v37, v100, v2, 0
  v_dot2_f32_bf16 v37, v101, v3, v37
  v_dot2_f32_bf16 v37, v102, v4, v37
  v_dot2_f32_bf16 v37, v103, v5, v37
  v_add_f32_dpp v38, v36, v36 row_ror:8 row_mask:0xf bank_mask:0x3
  s_nop 1
  v_add_f32_dpp v38, v37, v37 row_ror:8 row_mask:0xf bank_mask:0xc
  v_dot2_f32_bf16 v36, v104, v2, 0
  v_dot2_f32_bf16 v36, v105, v3, v36
  v_dot2_f32_bf16 v36, v106, v4, v36
  v_dot2_f32_bf16 v36, v107, v5, v36
  s_waitcnt vmcnt(6)
  buffer_load_dwordx4 v[200:203], v1, s[40:43], s14 offen offset:2048 nt
  v_dot2_f32_bf16 v37, v108, v2, 0
  v_dot2_f32_bf16 v37, v109, v3, v37
  v_dot2_f32_bf16 v37, v110, v4, v37
  v_dot2_f32_bf16 v37, v111, v5, v37
  v_add_f32_dpp v39, v36, v36 row_ror:8 row_mask:0xf bank_mask:0x3
  s_nop 1
  v_add_f32_dpp v39, v37, v37 row_ror:8 row_mask:0xf bank_mask:0xc
  v_add_f32_dpp v40, v38, v38 row_shl:4 row_mask:0xf bank_mask:0x5
  s_nop 0
  v_add_f32_dpp v40, v39, v39 row_shr:4 row_mask:0xf bank_mask:0xa
  v_dot2_f32_bf16 v36, v112, v2, 0
  v_dot2_f32_bf16 v36, v113, v3, v36
  v_dot2_f32_bf16 v36, v114, v4, v36
  v_dot2_f32_bf16 v36, v115, v5, v36
  v_dot2_f32_bf16 v37, v116, v2, 0
  v_dot2_f32_bf16 v37, v117, v3, v37
  v_dot2_f32_bf16 v37, v118, v4, v37
  v_dot2_f32_bf16 v37, v119, v5, v37
  v_add_f32_dpp v38, v36, v36 row_ror:8 row_mask:0xf bank_mask:0x3
  s_nop 1
  v_add_f32_dpp v38, v37, v37 row_ror:8 row_mask:0xf bank_mask:0xc
  s_waitcnt vmcnt(6)
  buffer_load_dwordx4 v[204:207], v1, s[40:43], s14 offen offset:3072 nt
  v_dot2_f32_bf16 v36, v120, v2, 0
  v_dot2_f32_bf16 v36, v121, v3, v36
  v_dot2_f32_bf16 v36, v122, v4, v36
  v_dot2_f32_bf16 v36, v123, v5, v36
  v_dot2_f32_bf16 v37, v124, v2, 0
  v_dot2_f32_bf16 v37, v125, v3, v37
  v_dot2_f32_bf16 v37, v126, v4, v37
  v_dot2_f32_bf16 v37, v127, v5, v37
  v_add_f32_dpp v39, v36, v36 row_ror:8 row_mask:0xf bank_mask:0x3
  s_nop 1
  v_add_f32_dpp v39, v37, v37 row_ror:8 row_mask:0xf bank_mask:0xc
  v_add_f32_dpp v41, v38, v38 row_shl:4 row_mask:0xf bank_mask:0x5
  s_nop 0
  v_add_f32_dpp v41, v39, v39 row_shr:4 row_mask:0xf bank_mask:0xa
  v_cndmask_b32 v44, v40, v41, s[64:65]
  v_cndmask_b32 v45, v41, v40, s[64:65]
  s_nop 1
  v_add_f32_dpp v43, v45, v44 quad_perm:[1,0,3,2] row_mask:0xf bank_mask:0xf
  v_cndmask_b32 v44, v42, v43, s[66:67]
  v_cndmask_b32 v45, v43, v42, s[66:67]
  s_nop 1
  v_add_f32_dpp v15, v45, v44 quad_perm:[2,3,0,1] row_mask:0xf bank_mask:0xf
  v_cvt_pk_bf16_f32 v15, v15, v15
  v_and_b32 v15, 0xffff0000, v15
  v_mul_f32 v15, s68, v15
  v_cvt_pk_bf16_f32 v15, v15, v15
  v_and_b32 v15, 0xffff0000, v15
  v_dot2_f32_bf16 v36, v128, v2, 0
  v_dot2_f32_bf16 v36, v129, v3, v36
  v_dot2_f32_bf16 v36, v130, v4, v36
  v_dot2_f32_bf16 v36, v131, v5, v36
  s_waitcnt vmcnt(6)
  s_add_u32 s14, s14, s15
  buffer_load_dwordx4 v[208:211], v1, s[40:43], s14 offen nt
  v_dot2_f32_bf16 v37, v132, v2, 0
  v_dot2_f32_bf16 v37, v133, v3, v37
  v_dot2_f32_bf16 v37, v134, v4, v37
  v_dot2_f32_bf16 v37, v135, v5, v37
  v_add_f32_dpp v38, v36, v36 row_ror:8 row_mask:0xf bank_mask:0x3
  s_nop 1
  v_add_f32_dpp v38, v37, v37 row_ror:8 row_mask:0xf bank_mask:0xc
  v_dot2_f32_bf16 v36, v136, v2, 0
  v_dot2_f32_bf16 v36, v137, v3, v36
  v_dot2_f32_bf16 v36, v138, v4, v36
  v_dot2_f32_bf16 v36, v139, v5, v36
  v_dot2_f32_bf16 v37, v140, v2, 0
  v_dot2_f32_bf16 v37, v141, v3, v37
  v_dot2_f32_bf16 v37, v142, v4, v37
  v_dot2_f32_bf16 v37, v143, v5, v37
  v_add_f32_dpp v39, v36, v36 row_ror:8 row_mask:0xf bank_mask:0x3
  s_nop 1
  v_add_f32_dpp v39, v37, v37 row_ror:8 row_mask:0xf bank_mask:0xc
  v_add_f32_dpp v40, v38, v38 row_shl:4 row_mask:0xf bank_mask:0x5
  s_nop 0
  v_add_f32_dpp v40, v39, v39 row_shr:4 row_mask:0xf bank_mask:0xa
  s_waitcnt vmcnt(6)
  buffer_load_dwordx4 v[212:215], v1, s[40:43], s14 offen offset:1024 nt
  v_dot2_f32_bf16 v36, v144, v2, 0
  v_dot2_f32_bf16 v36, v145, v3, v36
  v_dot2_f32_bf16 v36, v146, v4, v36
  v_dot2_f32_bf16 v36, v147, v5, v36
  v_dot2_f32_bf16 v37, v148, v2, 0
  v_dot2_f32_bf16 v37, v149, v3, v37
  v_dot2_f32_bf16 v37, v150, v4, v37
  v_dot2_f32_bf16 v37, v151, v5, v37
  v_add_f32_dpp v38, v36, v36 row_ror:8 row_mask:0xf bank_mask:0x3
  s_nop 1
  v_add_f32_dpp v38, v37, v37 row_ror:8 row_mask:0xf bank_mask:0xc
  v_dot2_f32_bf16 v36, v152, v2, 0
  v_dot2_f32_bf16 v36, v153, v3, v36
  v_dot2_f32_bf16 v36, v154, v4, v36
  v_dot2_f32_bf16 v36, v155, v5, v36
  s_waitcnt vmcnt(6)
  buffer_load_dwordx4 v[216:219], v1, s[40:43], s14 offen offset:2048 nt
  v_dot2_f32_bf16 v37, v156, v2, 0
  v_dot2_f32_bf16 v37, v157, v3, v37
  v_dot2_f32_bf16 v37, v158, v4, v37
  v_dot2_f32_bf16 v37, v159, v5, v37
  v_add_f32_dpp v39, v36, v36 row_ror:8 row_mask:0xf bank_mask:0x3
  s_nop 1
  v_add_f32_dpp v39, v37, v37 row_ror:8 row_mask:0xf bank_mask:0xc
  v_add_f32_dpp v41, v38, v38 row_shl:4 row_mask:0xf bank_mask:0x5
  s_nop 0
  v_add_f32_dpp v41, v39, v39 row_shr:4 row_mask:0xf bank_mask:0xa
  v_cndmask_b32 v44, v40, v41, s[64:65]
  v_cndmask_b32 v45, v41, v40, s[64:65]
  s_nop 1
  v_add_f32_dpp v42, v45, v44 quad_perm:[1,0,3,2] row_mask:0xf bank_mask:0xf
  v_dot2_f32_bf16 v36, v160, v2, 0
  v_dot2_f32_bf16 v36, v161, v3, v36
  v_dot2_f32_bf16 v36, v162, v4, v36
  v_dot2_f32_bf16 v36, v163, v5, v36
  v_dot2_f32_bf16 v37, v164, v2, 0
  v_dot2_f32_bf16 v37, v165, v3, v37
  v_dot2_f32_bf16 v37, v166, v4, v37
  v_dot2_f32_bf16 v37, v167, v5, v37
  v_add_f32_dpp v38, v36, v36 row_ror:8 row_mask:0xf bank_mask:0x3
  s_nop 1
  v_add_f32_dpp v38, v37, v37 row_ror:8 row_mask:0xf bank_mask:0xc
  s_waitcnt vmcnt(6)
  buffer_load_dwordx4 v[220:223], v1, s[40:43], s14 offen offset:3072 nt
  v_dot2_f32_bf16 v36, v168, v2, 0
  v_dot2_f32_bf16 v36, v169, v3, v36
  v_dot2_f32_bf16 v36, v170, v4, v36
  v_dot2_f32_bf16 v36, v171, v5, v36
  v_dot2_f32_bf16 v37, v172, v2, 0
  v_dot2_f32_bf16 v37, v173, v3, v37
  v_dot2_f32_bf16 v37, v174, v4, v37
  v_dot2_f32_bf16 v37, v175, v5, v37
  v_add_f32_dpp v39, v36, v36 row_ror:8 row_mask:0xf bank_mask:0x3
  s_nop 1
  v_add_f32_dpp v39, v37, v37 row_ror:8 row_mask:0xf bank_mask:0xc
  v_add_f32_dpp v40, v38, v38 row_shl:4 row_mask:0xf bank_mask:0x5
  s_nop 0
  v_add_f32_dpp v40, v39, v39 row_shr:4 row_mask:0xf bank_mask:0xa
  v_dot2_f32_bf16 v36, v176, v2, 0
  v_dot2_f32_bf16 v36, v177, v3, v36
  v_dot2_f32_bf16 v36, v178, v4, v36
  v_dot2_f32_bf16 v36, v179, v5, v36
  s_waitcnt vmcnt(6)
  s_add_u32 s14, s14, s15
  buffer_load_dwordx4 v[224:227], v1, s[40:43], s14 offen nt
  v_dot2_f32_bf16 v37, v180, v2, 0
  v_dot2_f32_bf16 v37, v181, v3, v37
  v_dot2_f32_bf16 v37, v182, v4, v37
  v_dot2_f32_bf16 v37, v183, v5, v37
  v_add_f32_dpp v38, v36, v36 row_ror:8 row_mask:0xf bank_mask:0x3
  s_nop 1
  v_add_f32_dpp v38, v37, v37 row_ror:8 row_mask:0xf bank_mask:0xc
  v_dot2_f32_bf16 v36, v184, v2, 0
  v_dot2_f32_bf16 v36, v185, v3, v36
  v_dot2_f32_bf16 v36, v186, v4, v36
  v_dot2_f32_bf16 v36, v187, v5, v36
  s_waitcnt vmcnt(6)
  buffer_load_dwordx4 v[228:231], v1, s[40:43], s14 offen offset:1024 nt
  v_dot2_f32_bf16 v37, v188, v2, 0
  v_dot2_f32_bf16 v37, v189, v3, v37
  v_dot2_f32_bf16 v37, v190, v4, v37
  v_dot2_f32_bf16 v37, v191, v5, v37
  v_add_f32_dpp v39, v36, v36 row_ror:8 row_mask:0xf bank_mask:0x3
  s_nop 1
  v_add_f32_dpp v39, v37, v37 row_ror:8 row_mask:0xf bank_mask:0xc
  v_add_f32_dpp v41, v38, v38 row_shl:4 row_mask:0xf bank_mask:0x5
  s_nop 0
  v_add_f32_dpp v41, v39, v39 row_shr:4 row_mask:0xf bank_mask:0xa
  v_cndmask_b32 v44, v40, v41, s[64:65]
  v_cndmask_b32 v45, v41, v40, s[64:65]
  s_nop 1
  v_add_f32_dpp v43, v45, v44 quad_perm:[1,0,3,2] row_mask:0xf bank_mask:0xf
  v_cndmask_b32 v44, v42, v43, s[66:67]
  v_cndmask_b32 v45, v43, v42, s[66:67]
  s_nop 1
  v_add_f32_dpp v16, v45, v44 quad_perm:[2,3,0,1] row_mask:0xf bank_mask:0xf
  v_cvt_pk_bf16_f32 v16, v16, v16
  v_and_b32 v16, 0xffff0000, v16
  v_mul_f32 v16, s68, v16
  v_cvt_pk_bf16_f32 v16, v16, v16
  v_and_b32 v16, 0xffff0000, v16
  s_waitcnt vmcnt(6)
  buffer_load_dwordx4 v[232:235], v1, s[40:43], s14 offen offset:2048 nt
  v_dot2_f32_bf16 v36, v192, v2, 0
  v_dot2_f32_bf16 v36, v193, v3, v36
  v_dot2_f32_bf16 v36, v194, v4, v36
  v_dot2_f32_bf16 v36, v195, v5, v36
  s_waitcnt vmcnt(6)
  buffer_load_dwordx4 v[236:239], v1, s[40:43], s14 offen offset:3072 nt
  v_dot2_f32_bf16 v37, v196, v2, 0
  v_dot2_f32_bf16 v37, v197, v3, v37
  v_dot2_f32_bf16 v37, v198, v4, v37
  v_dot2_f32_bf16 v37, v199, v5, v37
  v_add_f32_dpp v38, v36, v36 row_ror:8 row_mask:0xf bank_mask:0x3
  s_nop 1
  v_add_f32_dpp v38, v37, v37 row_ror:8 row_mask:0xf bank_mask:0xc
  s_waitcnt vmcnt(6)
  s_add_u32 s14, s14, s15
  buffer_load_dwordx4 v[240:243], v1, s[40:43], s14 offen nt
  v_dot2_f32_bf16 v36, v200, v2, 0
  v_dot2_f32_bf16 v36, v201, v3, v36
  v_dot2_f32_bf16 v36, v202, v4, v36
  v_dot2_f32_bf16 v36, v203, v5, v36
  s_waitcnt vmcnt(6)
  buffer_load_dwordx4 v[244:247], v1, s[40:43], s14 offen offset:1024 nt
  v_dot2_f32_bf16 v37, v204, v2, 0
  v_dot2_f32_bf16 v37, v205, v3, v37
  v_dot2_f32_bf16 v37, v206, v4, v37
  v_dot2_f32_bf16 v37, v207, v5, v37
  v_add_f32_dpp v39, v36, v36 row_ror:8 row_mask:0xf bank_mask:0x3
  s_nop 1
  v_add_f32_dpp v39, v37, v37 row_ror:8 row_mask:0xf bank_mask:0xc
  v_add_f32_dpp v40, v38, v38 row_shl:4 row_mask:0xf bank_mask:0x5
  s_nop 0
  v_add_f32_dpp v40, v39, v39 row_shr:4 row_mask:0xf bank_mask:0xa
  s_waitcnt vmcnt(6)
  buffer_load_dwordx4 v[248:251], v1, s[40:43], s14 offen offset:2048 nt
  v_dot2_f32_bf16 v36, v208, v2, 0
  v_dot2_f32_bf16 v36, v209, v3, v36
  v_dot2_f32_bf16 v36, v210, v4, v36
  v_dot2_f32_bf16 v36, v211, v5, v36
  s_waitcnt vmcnt(6)
  buffer_load_dwordx4 v[252:255], v1, s[40:43], s14 offen offset:3072 nt
  v_dot2_f32_bf16 v37, v212, v2, 0
  v_dot2_f32_bf16 v37, v213, v3, v37
  v_dot2_f32_bf16 v37, v214, v4, v37
  v_dot2_f32_bf16 v37, v215, v5, v37
  v_add_f32_dpp v38, v36, v36 row_ror:8 row_mask:0xf bank_mask:0x3
  s_nop 1
  v_add_f32_dpp v38, v37, v37 row_ror:8 row_mask:0xf bank_mask:0xc
  s_waitcnt vmcnt(6)
  s_add_u32 s14, s14, s15
  buffer_load_dwordx4 v[64:67], v1, s[40:43], s14 offen nt
  v_dot2_f32_bf16 v36, v216, v2, 0
  v_dot2_f32_bf16 v36, v217, v3, v36
  v_dot2_f32_bf16 v36, v218, v4, v36
  v_dot2_f32_bf16 v36, v219, v5, v36
  s_waitcnt vmcnt(6)
  buffer_load_dwordx4 v[68:71], v1, s[40:43], s14 offen offset:1024 nt
  v_dot2_f32_bf16 v37, v220, v2, 0
  v_dot2_f32_bf16 v37, v221, v3, v37
  v_dot2_f32_bf16 v37, v222, v4, v37
  v_dot2_f32_bf16 v37, v223, v5, v37
  v_add_f32_dpp v39, v36, v36 row_ror:8 row_mask:0xf bank_mask:0x3
  s_nop 1
  v_add_f32_dpp v39, v37, v37 row_ror:8 row_mask:0xf bank_mask:0xc
  v_add_f32_dpp v41, v38, v38 row_shl:4 row_mask:0xf bank_mask:0x5
  s_nop 0
  v_add_f32_dpp v41, v39, v39 row_shr:4 row_mask:0xf bank_mask:0xa
  v_cndmask_b32 v44, v40, v41, s[64:65]
  v_cndmask_b32 v45, v41, v40, s[64:65]
  s_nop 1
  v_add_f32_dpp v42, v45, v44 quad_perm:[1,0,3,2] row_mask:0xf bank_mask:0xf
  s_waitcnt vmcnt(6)
  buffer_load_dwordx4 v[72:75], v1, s[40:43], s14 offen offset:2048 nt
  v_dot2_f32_bf16 v36, v224, v2, 0
  v_dot2_f32_bf16 v36, v225, v3, v36
  v_dot2_f32_bf16 v36, v226, v4, v36
  v_dot2_f32_bf16 v36, v227, v5, v36
  s_waitcnt vmcnt(6)
  buffer_load_dwordx4 v[76:79], v1, s[40:43], s14 offen offset:3072 nt
  v_dot2_f32_bf16 v37, v228, v2, 0
  v_dot2_f32_bf16 v37, v229, v3, v37
  v_dot2_f32_bf16 v37, v230, v4, v37
  v_dot2_f32_bf16 v37, v231, v5, v37
  v_add_f32_dpp v38, v36, v36 row_ror:8 row_mask:0xf bank_mask:0x3
  s_nop 1
  v_add_f32_dpp v38, v37, v37 row_ror:8 row_mask:0xf bank_mask:0xc
  s_waitcnt vmcnt(6)
  s_add_u32 s14, s14, s15
  buffer_load_dwordx4 v[80:83], v1, s[40:43], s14 offen nt
  v_dot2_f32_bf16 v36, v232, v2, 0
  v_dot2_f32_bf16 v36, v233, v3, v36
  v_dot2_f32_bf16 v36, v234, v4, v36
  v_dot2_f32_bf16 v36, v235, v5, v36
  s_waitcnt vmcnt(6)
  buffer_load_dwordx4 v[84:87], v1, s[40:43], s14 offen offset:1024 nt
  v_dot2_f32_bf16 v37, v236, v2, 0
  v_dot2_f32_bf16 v37, v237, v3, v37
  v_dot2_f32_bf16 v37, v238, v4, v37
  v_dot2_f32_bf16 v37, v239, v5, v37
  v_add_f32_dpp v39, v36, v36 row_ror:8 row_mask:0xf bank_mask:0x3
  s_nop 1
  v_add_f32_dpp v39, v37, v37 row_ror:8 row_mask:0xf bank_mask:0xc
  v_add_f32_dpp v40, v38, v38 row_shl:4 row_mask:0xf bank_mask:0x5
  s_nop 0
  v_add_f32_dpp v40, v39, v39 row_shr:4 row_mask:0xf bank_mask:0xa
  s_waitcnt vmcnt(6)
  buffer_load_dwordx4 v[88:91], v1, s[40:43], s14 offen offset:2048 nt
  v_dot2_f32_bf16 v36, v240, v2, 0
  v_dot2_f32_bf16 v36, v241, v3, v36
  v_dot2_f32_bf16 v36, v242, v4, v36
  v_dot2_f32_bf16 v36, v243, v5, v36
  s_waitcnt vmcnt(6)
  buffer_load_dwordx4 v[92:95], v1, s[40:43], s14 offen offset:3072 nt
  v_dot2_f32_bf16 v37, v244, v2, 0
  v_dot2_f32_bf16 v37, v245, v3, v37
  v_dot2_f32_bf16 v37, v246, v4, v37
  v_dot2_f32_bf16 v37, v247, v5, v37
  v_add_f32_dpp v38, v36, v36 row_ror:8 row_mask:0xf bank_mask:0x3
  s_nop 1
  v_add_f32_dpp v38, v37, v37 row_ror:8 row_mask:0xf bank_mask:0xc
  s_waitcnt vmcnt(6)
  s_add_u32 s14, s14, s15
  buffer_load_dwordx4 v[96:99], v1, s[40:43], s14 offen nt
  v_dot2_f32_bf16 v36, v248, v2, 0
  v_dot2_f32_bf16 v36, v249, v3, v36
  v_dot2_f32_bf16 v36, v250, v4, v36
  v_dot2_f32_bf16 v36, v251, v5, v36
  s_waitcnt vmcnt(6)
  buffer_load_dwordx4 v[100:103], v1, s[40:43], s14 offen offset:1024 nt
  v_dot2_f32_bf16 v37, v252, v2, 0
  v_dot2_f32_bf16 v37, v253, v3, v37
  v_dot2_f32_bf16 v37, v254, v4, v37
  v_dot2_f32_bf16 v37, v255, v5, v37
  v_add_f32_dpp v39, v36, v36 row_ror:8 row_mask:0xf bank_mask:0x3
  s_nop 1
  v_add_f32_dpp v39, v37, v37 row_ror:8 row_mask:0xf bank_mask:0xc
  v_add_f32_dpp v41, v38, v38 row_shl:4 row_mask:0xf bank_mask:0x5
  s_nop 0
  v_add_f32_dpp v41, v39, v39 row_shr:4 row_mask:0xf bank_mask:0xa
  v_cndmask_b32 v44, v40, v41, s[64:65]
  v_cndmask_b32 v45, v41, v40, s[64:65]
  s_nop 1
  v_add_f32_dpp v43, v45, v44 quad_perm:[1,0,3,2] row_mask:0xf bank_mask:0xf
  v_cndmask_b32 v44, v42, v43, s[66:67]
  v_cndmask_b32 v45, v43, v42, s[66:67]
  s_nop 1
  v_add_f32_dpp v17, v45, v44 quad_perm:[2,3,0,1] row_mask:0xf bank_mask:0xf
  v_cvt_pk_bf16_f32 v17, v17, v17
  v_and_b32 v17, 0xffff0000, v17
  v_mul_f32 v17, s68, v17
  v_cvt_pk_bf16_f32 v17, v17, v17
  v_and_b32 v17, 0xffff0000, v17
  s_waitcnt vmcnt(6)
  buffer_load_dwordx4 v[104:107], v1, s[40:43], s14 offen offset:2048 nt
  v_dot2_f32_bf16 v36, v64, v2, 0
  v_dot2_f32_bf16 v36, v65, v3, v36
  v_dot2_f32_bf16 v36, v66, v4, v36
  v_dot2_f32_bf16 v36, v67, v5, v36
  s_waitcnt vmcnt(6)
  buffer_load_dwordx4 v[108:111], v1, s[40:43], s14 offen offset:3072 nt
  v_dot2_f32_bf16 v37, v68, v2, 0
  v_dot2_f32_bf16 v37, v69, v3, v37
  v_dot2_f32_bf16 v37, v70, v4, v37
  v_dot2_f32_bf16 v37, v71, v5, v37
  v_add_f32_dpp v38, v36, v36 row_ror:8 row_mask:0xf bank_mask:0x3
  s_nop 1
  v_add_f32_dpp v38, v37, v37 row_ror:8 row_mask:0xf bank_mask:0xc
  s_waitcnt vmcnt(6)
  s_add_u32 s14, s14, s15
  buffer_load_dwordx4 v[112:115], v1, s[40:43], s14 offen nt
  v_dot2_f32_bf16 v36, v72, v2, 0
  v_dot2_f32_bf16 v36, v73, v3, v36
  v_dot2_f32_bf16 v36, v74, v4, v36
  v_dot2_f32_bf16 v36, v75, v5, v36
  s_waitcnt vmcnt(6)
  buffer_load_dwordx4 v[116:119], v1, s[40:43], s14 offen offset:1024 nt
  v_dot2_f32_bf16 v37, v76, v2, 0
  v_dot2_f32_bf16 v37, v77, v3, v37
  v_dot2_f32_bf16 v37, v78, v4, v37
  v_dot2_f32_bf16 v37, v79, v5, v37
  v_add_f32_dpp v39, v36, v36 row_ror:8 row_mask:0xf bank_mask:0x3
  s_nop 1
  v_add_f32_dpp v39, v37, v37 row_ror:8 row_mask:0xf bank_mask:0xc
  v_add_f32_dpp v40, v38, v38 row_shl:4 row_mask:0xf bank_mask:0x5
  s_nop 0
  v_add_f32_dpp v40, v39, v39 row_shr:4 row_mask:0xf bank_mask:0xa
  s_waitcnt vmcnt(6)
  buffer_load_dwordx4 v[120:123], v1, s[40:43], s14 offen offset:2048 nt
  v_dot2_f32_bf16 v36, v80, v2, 0
  v_dot2_f32_bf16 v36, v81, v3, v36
  v_dot2_f32_bf16 v36, v82, v4, v36
  v_dot2_f32_bf16 v36, v83, v5, v36
  s_waitcnt vmcnt(6)
  buffer_load_dwordx4 v[124:127], v1, s[40:43], s14 offen offset:3072 nt
  v_dot2_f32_bf16 v37, v84, v2, 0
  v_dot2_f32_bf16 v37, v85, v3, v37
  v_dot2_f32_bf16 v37, v86, v4, v37
  v_dot2_f32_bf16 v37, v87, v5, v37
  v_add_f32_dpp v38, v36, v36 row_ror:8 row_mask:0xf bank_mask:0x3
  s_nop 1
  v_add_f32_dpp v38, v37, v37 row_ror:8 row_mask:0xf bank_mask:0xc
  s_waitcnt vmcnt(6)
  s_add_u32 s14, s14, s15
  buffer_load_dwordx4 v[128:131], v1, s[40:43], s14 offen nt
  v_dot2_f32_bf16 v36, v88, v2, 0
  v_dot2_f32_bf16 v36, v89, v3, v36
  v_dot2_f32_bf16 v36, v90, v4, v36
  v_dot2_f32_bf16 v36, v91, v5, v36
  s_waitcnt vmcnt(6)
  buffer_load_dwordx4 v[132:135], v1, s[40:43], s14 offen offset:1024 nt
  v_dot2_f32_bf16 v37, v92, v2, 0
  v_dot2_f32_bf16 v37, v93, v3, v37
  v_dot2_f32_bf16 v37, v94, v4, v37
  v_dot2_f32_bf16 v37, v95, v5, v37
  v_add_f32_dpp v39, v36, v36 row_ror:8 row_mask:0xf bank_mask:0x3
  s_nop 1
  v_add_f32_dpp v39, v37, v37 row_ror:8 row_mask:0xf bank_mask:0xc
  v_add_f32_dpp v41, v38, v38 row_shl:4 row_mask:0xf bank_mask:0x5
  s_nop 0
  v_add_f32_dpp v41, v39, v39 row_shr:4 row_mask:0xf bank_mask:0xa
  v_cndmask_b32 v44, v40, v41, s[64:65]
  v_cndmask_b32 v45, v41, v40, s[64:65]
  s_nop 1
  v_add_f32_dpp v42, v45, v44 quad_perm:[1,0,3,2] row_mask:0xf bank_mask:0xf
  s_waitcnt vmcnt(6)
  buffer_load_dwordx4 v[136:139], v1, s[40:43], s14 offen offset:2048 nt
  v_dot2_f32_bf16 v36, v96, v2, 0
  v_dot2_f32_bf16 v36, v97, v3, v36
  v_dot2_f32_bf16 v36, v98, v4, v36
  v_dot2_f32_bf16 v36, v99, v5, v36
  s_waitcnt vmcnt(6)
  buffer_load_dwordx4 v[140:143], v1, s[40:43], s14 offen offset:3072 nt
  v_dot2_f32_bf16 v37, v100, v2, 0
  v_dot2_f32_bf16 v37, v101, v3, v37
  v_dot2_f32_bf16 v37, v102, v4, v37
  v_dot2_f32_bf16 v37, v103, v5, v37
  v_add_f32_dpp v38, v36, v36 row_ror:8 row_mask:0xf bank_mask:0x3
  s_nop 1
  v_add_f32_dpp v38, v37, v37 row_ror:8 row_mask:0xf bank_mask:0xc
  s_waitcnt vmcnt(6)
  s_add_u32 s14, s14, s15
  buffer_load_dwordx4 v[144:147], v1, s[40:43], s14 offen nt
  v_dot2_f32_bf16 v36, v104, v2, 0
  v_dot2_f32_bf16 v36, v105, v3, v36
  v_dot2_f32_bf16 v36, v106, v4, v36
  v_dot2_f32_bf16 v36, v107, v5, v36
  s_waitcnt vmcnt(6)
  buffer_load_dwordx4 v[148:151], v1, s[40:43], s14 offen offset:1024 nt
  v_dot2_f32_bf16 v37, v108, v2, 0
  v_dot2_f32_bf16 v37, v109, v3, v37
  v_dot2_f32_bf16 v37, v110, v4, v37
  v_dot2_f32_bf16 v37, v111, v5, v37
  v_add_f32_dpp v39, v36, v36 row_ror:8 row_mask:0xf bank_mask:0x3
  s_nop 1
  v_add_f32_dpp v39, v37, v37 row_ror:8 row_mask:0xf bank_mask:0xc
  v_add_f32_dpp v40, v38, v38 row_shl:4 row_mask:0xf bank_mask:0x5
  s_nop 0
  v_add_f32_dpp v40, v39, v39 row_shr:4 row_mask:0xf bank_mask:0xa
  s_waitcnt vmcnt(6)
  buffer_load_dwordx4 v[152:155], v1, s[40:43], s14 offen offset:2048 nt
  v_dot2_f32_bf16 v36, v112, v2, 0
  v_dot2_f32_bf16 v36, v113, v3, v36
  v_dot2_f32_bf16 v36, v114, v4, v36
  v_dot2_f32_bf16 v36, v115, v5, v36
  s_waitcnt vmcnt(6)
  buffer_load_dwordx4 v[156:159], v1, s[40:43], s14 offen offset:3072 nt
  v_dot2_f32_bf16 v37, v116, v2, 0
  v_dot2_f32_bf16 v37, v117, v3, v37
  v_dot2_f32_bf16 v37, v118, v4, v37
  v_dot2_f32_bf16 v37, v119, v5, v37
  v_add_f32_dpp v38, v36, v36 row_ror:8 row_mask:0xf bank_mask:0x3
  s_nop 1
  v_add_f32_dpp v38, v37, v37 row_ror:8 row_mask:0xf bank_mask:0xc
  s_waitcnt vmcnt(6)
  s_add_u32 s14, s14, s15
  buffer_load_dwordx4 v[160:163], v1, s[40:43], s14 offen nt
  v_dot2_f32_bf16 v36, v120, v2, 0
  v_dot2_f32_bf16 v36, v121, v3, v36
  v_dot2_f32_bf16 v36, v122, v4, v36
  v_dot2_f32_bf16 v36, v123, v5, v36
  s_waitcnt vmcnt(6)
  buffer_load_dwordx4 v[164:167], v1, s[40:43], s14 offen offset:1024 nt
  v_dot2_f32_bf16 v37, v124, v2, 0
  v_dot2_f32_bf16 v37, v125, v3, v37
  v_dot2_f32_bf16 v37, v126, v4, v37
  v_dot2_f32_bf16 v37, v127, v5, v37
  v_add_f32_dpp v39, v36, v36 row_ror:8 row_mask:0xf bank_mask:0x3
  s_nop 1
  v_add_f32_dpp v39, v37, v37 row_ror:8 row_mask:0xf bank_mask:0xc
  v_add_f32_dpp v41, v38, v38 row_shl:4 row_mask:0xf bank_mask:0x5
  s_nop 0
  v_add_f32_dpp v41, v39, v39 row_shr:4 row_mask:0xf bank_mask:0xa
  v_cndmask_b32 v44, v40, v41, s[64:65]
  v_cndmask_b32 v45, v41, v40, s[64:65]
  s_nop 1
  v_add_f32_dpp v43, v45, v44 quad_perm:[1,0,3,2] row_mask:0xf bank_mask:0xf
  v_cndmask_b32 v44, v42, v43, s[66:67]
  v_cndmask_b32 v45, v43, v42, s[66:67]
  s_nop 1
  v_add_f32_dpp v18, v45, v44 quad_perm:[2,3,0,1] row_mask:0xf bank_mask:0xf
  v_cvt_pk_bf16_f32 v18, v18, v18
  v_and_b32 v18, 0xffff0000, v18
  v_mul_f32 v18, s68, v18
  v_cvt_pk_bf16_f32 v18, v18, v18
  v_and_b32 v18, 0xffff0000, v18
  s_waitcnt vmcnt(6)
  buffer_load_dwordx4 v[168:171], v1, s[40:43], s14 offen offset:2048 nt
  v_dot2_f32_bf16 v36, v128, v2, 0
  v_dot2_f32_bf16 v36, v129, v3, v36
  v_dot2_f32_bf16 v36, v130, v4, v36
  v_dot2_f32_bf16 v36, v131, v5, v36
  s_waitcnt vmcnt(6)
  buffer_load_dwordx4 v[172:175], v1, s[40:43], s14 offen offset:3072 nt
  v_dot2_f32_bf16 v37, v132, v2, 0
  v_dot2_f32_bf16 v37, v133, v3, v37
  v_dot2_f32_bf16 v37, v134, v4, v37
  v_dot2_f32_bf16 v37, v135, v5, v37
  v_add_f32_dpp v38, v36, v36 row_ror:8 row_mask:0xf bank_mask:0x3
  s_nop 1
  v_add_f32_dpp v38, v37, v37 row_ror:8 row_mask:0xf bank_mask:0xc
  s_waitcnt vmcnt(6)
  s_add_u32 s14, s14, s15
  buffer_load_dwordx4 v[176:179], v1, s[40:43], s14 offen nt
  v_dot2_f32_bf16 v36, v136, v2, 0
  v_dot2_f32_bf16 v36, v137, v3, v36
  v_dot2_f32_bf16 v36, v138, v4, v36
  v_dot2_f32_bf16 v36, v139, v5, v36
  s_waitcnt vmcnt(6)
  buffer_load_dwordx4 v[180:183], v1, s[40:43], s14 offen offset:1024 nt
  v_dot2_f32_bf16 v37, v140, v2, 0
  v_dot2_f32_bf16 v37, v141, v3, v37
  v_dot2_f32_bf16 v37, v142, v4, v37
  v_dot2_f32_bf16 v37, v143, v5, v37
  v_add_f32_dpp v39, v36, v36 row_ror:8 row_mask:0xf bank_mask:0x3
  s_nop 1
  v_add_f32_dpp v39, v37, v37 row_ror:8 row_mask:0xf bank_mask:0xc
  v_add_f32_dpp v40, v38, v38 row_shl:4 row_mask:0xf bank_mask:0x5
  s_nop 0
  v_add_f32_dpp v40, v39, v39 row_shr:4 row_mask:0xf bank_mask:0xa
  s_waitcnt vmcnt(6)
  buffer_load_dwordx4 v[184:187], v1, s[40:43], s14 offen offset:2048 nt
  v_dot2_f32_bf16 v36, v144, v2, 0
  v_dot2_f32_bf16 v36, v145, v3, v36
  v_dot2_f32_bf16 v36, v146, v4, v36
  v_dot2_f32_bf16 v36, v147, v5, v36
  s_waitcnt vmcnt(6)
  buffer_load_dwordx4 v[188:191], v1, s[40:43], s14 offen offset:3072 nt
  v_dot2_f32_bf16 v37, v148, v2, 0
  v_dot2_f32_bf16 v37, v149, v3, v37
  v_dot2_f32_bf16 v37, v150, v4, v37
  v_dot2_f32_bf16 v37, v151, v5, v37
  v_add_f32_dpp v38, v36, v36 row_ror:8 row_mask:0xf bank_mask:0x3
  s_nop 1
  v_add_f32_dpp v38, v37, v37 row_ror:8 row_mask:0xf bank_mask:0xc
  s_waitcnt vmcnt(6)
  s_add_u32 s14, s14, s15
  buffer_load_dwordx4 v[192:195], v1, s[40:43], s14 offen nt
  v_dot2_f32_bf16 v36, v152, v2, 0
  v_dot2_f32_bf16 v36, v153, v3, v36
  v_dot2_f32_bf16 v36, v154, v4, v36
  v_dot2_f32_bf16 v36, v155, v5, v36
  s_waitcnt vmcnt(6)
  buffer_load_dwordx4 v[196:199], v1, s[40:43], s14 offen offset:1024 nt
  v_dot2_f32_bf16 v37, v156, v2, 0
  v_dot2_f32_bf16 v37, v157, v3, v37
  v_dot2_f32_bf16 v37, v158, v4, v37
  v_dot2_f32_bf16 v37, v159, v5, v37
  v_add_f32_dpp v39, v36, v36 row_ror:8 row_mask:0xf bank_mask:0x3
  s_nop 1
  v_add_f32_dpp v39, v37, v37 row_ror:8 row_mask:0xf bank_mask:0xc
  v_add_f32_dpp v41, v38, v38 row_shl:4 row_mask:0xf bank_mask:0x5
  s_nop 0
  v_add_f32_dpp v41, v39, v39 row_shr:4 row_mask:0xf bank_mask:0xa
  v_cndmask_b32 v44, v40, v41, s[64:65]
  v_cndmask_b32 v45, v41, v40, s[64:65]
  s_nop 1
  v_add_f32_dpp v42, v45, v44 quad_perm:[1,0,3,2] row_mask:0xf bank_mask:0xf
  s_waitcnt vmcnt(6)
  buffer_load_dwordx4 v[200:203], v1, s[40:43], s14 offen offset:2048 nt
  v_dot2_f32_bf16 v36, v160, v2, 0
  v_dot2_f32_bf16 v36, v161, v3, v36
  v_dot2_f32_bf16 v36, v162, v4, v36
  v_dot2_f32_bf16 v36, v163, v5, v36
  s_waitcnt vmcnt(6)
  buffer_load_dwordx4 v[204:207], v1, s[40:43], s14 offen offset:3072 nt
  v_dot2_f32_bf16 v37, v164, v2, 0
  v_dot2_f32_bf16 v37, v165, v3, v37
  v_dot2_f32_bf16 v37, v166, v4, v37
  v_dot2_f32_bf16 v37, v167, v5, v37
  v_add_f32_dpp v38, v36, v36 row_ror:8 row_mask:0xf bank_mask:0x3
  s_nop 1
  v_add_f32_dpp v38, v37, v37 row_ror:8 row_mask:0xf bank_mask:0xc
  s_waitcnt vmcnt(6)
  s_add_u32 s14, s14, s15
  buffer_load_dwordx4 v[208:211], v1, s[40:43], s14 offen nt
  v_dot2_f32_bf16 v36, v168, v2, 0
  v_dot2_f32_bf16 v36, v169, v3, v36
  v_dot2_f32_bf16 v36, v170, v4, v36
  v_dot2_f32_bf16 v36, v171, v5, v36
  s_waitcnt vmcnt(6)
  buffer_load_dwordx4 v[212:215], v1, s[40:43], s14 offen offset:1024 nt
  v_dot2_f32_bf16 v37, v172, v2, 0
  v_dot2_f32_bf16 v37, v173, v3, v37
  v_dot2_f32_bf16 v37, v174, v4, v37
  v_dot2_f32_bf16 v37, v175, v5, v37
  v_add_f32_dpp v39, v36, v36 row_ror:8 row_mask:0xf bank_mask:0x3
  s_nop 1
  v_add_f32_dpp v39, v37, v37 row_ror:8 row_mask:0xf bank_mask:0xc
  v_add_f32_dpp v40, v38, v38 row_shl:4 row_mask:0xf bank_mask:0x5
  s_nop 0
  v_add_f32_dpp v40, v39, v39 row_shr:4 row_mask:0xf bank_mask:0xa
  s_waitcnt vmcnt(6)
  buffer_load_dwordx4 v[216:219], v1, s[40:43], s14 offen offset:2048 nt
  v_dot2_f32_bf16 v36, v176, v2, 0
  v_dot2_f32_bf16 v36, v177, v3, v36
  v_dot2_f32_bf16 v36, v178, v4, v36
  v_dot2_f32_bf16 v36, v179, v5, v36
  s_waitcnt vmcnt(6)
  buffer_load_dwordx4 v[220:223], v1, s[40:43], s14 offen offset:3072 nt
  v_dot2_f32_bf16 v37, v180, v2, 0
  v_dot2_f32_bf16 v37, v181, v3, v37
  v_dot2_f32_bf16 v37, v182, v4, v37
  v_dot2_f32_bf16 v37, v183, v5, v37
  v_add_f32_dpp v38, v36, v36 row_ror:8 row_mask:0xf bank_mask:0x3
  s_nop 1
  v_add_f32_dpp v38, v37, v37 row_ror:8 row_mask:0xf bank_mask:0xc
  s_waitcnt vmcnt(6)
  s_add_u32 s14, s14, s15
  buffer_load_dwordx4 v[224:227], v1, s[40:43], s14 offen nt
  v_dot2_f32_bf16 v36, v184, v2, 0
  v_dot2_f32_bf16 v36, v185, v3, v36
  v_dot2_f32_bf16 v36, v186, v4, v36
  v_dot2_f32_bf16 v36, v187, v5, v36
  s_waitcnt vmcnt(6)
  buffer_load_dwordx4 v[228:231], v1, s[40:43], s14 offen offset:1024 nt
  v_dot2_f32_bf16 v37, v188, v2, 0
  v_dot2_f32_bf16 v37, v189, v3, v37
  v_dot2_f32_bf16 v37, v190, v4, v37
  v_dot2_f32_bf16 v37, v191, v5, v37
  v_add_f32_dpp v39, v36, v36 row_ror:8 row_mask:0xf bank_mask:0x3
  s_nop 1
  v_add_f32_dpp v39, v37, v37 row_ror:8 row_mask:0xf bank_mask:0xc
  v_add_f32_dpp v41, v38, v38 row_shl:4 row_mask:0xf bank_mask:0x5
  s_nop 0
  v_add_f32_dpp v41, v39, v39 row_shr:4 row_mask:0xf bank_mask:0xa
  v_cndmask_b32 v44, v40, v41, s[64:65]
  v_cndmask_b32 v45, v41, v40, s[64:65]
  s_nop 1
  v_add_f32_dpp v43, v45, v44 quad_perm:[1,0,3,2] row_mask:0xf bank_mask:0xf
  v_cndmask_b32 v44, v42, v43, s[66:67]
  v_cndmask_b32 v45, v43, v42, s[66:67]
  s_nop 1
  v_add_f32_dpp v19, v45, v44 quad_perm:[2,3,0,1] row_mask:0xf bank_mask:0xf
  v_cvt_pk_bf16_f32 v19, v19, v19
  v_and_b32 v19, 0xffff0000, v19
  v_mul_f32 v19, s68, v19
  v_cvt_pk_bf16_f32 v19, v19, v19
  v_and_b32 v19, 0xffff0000, v19
  s_waitcnt vmcnt(6)
  buffer_load_dwordx4 v[232:235], v1, s[40:43], s14 offen offset:2048 nt
  v_dot2_f32_bf16 v36, v192, v2, 0
  v_dot2_f32_bf16 v36, v193, v3, v36
  v_dot2_f32_bf16 v36, v194, v4, v36
  v_dot2_f32_bf16 v36, v195, v5, v36
  s_waitcnt vmcnt(6)
  buffer_load_dwordx4 v[236:239], v1, s[40:43], s14 offen offset:3072 nt
  v_dot2_f32_bf16 v37, v196, v2, 0
  v_dot2_f32_bf16 v37, v197, v3, v37
  v_dot2_f32_bf16 v37, v198, v4, v37
  v_dot2_f32_bf16 v37, v199, v5, v37
  v_add_f32_dpp v38, v36, v36 row_ror:8 row_mask:0xf bank_mask:0x3
  s_nop 1
  v_add_f32_dpp v38, v37, v37 row_ror:8 row_mask:0xf bank_mask:0xc
  s_waitcnt vmcnt(6)
  s_mov_b32 s14, 0x0
  buffer_load_dwordx4 v[240:243], v1, s[44:47], s14 offen nt
  v_dot2_f32_bf16 v36, v200, v2, 0
  v_dot2_f32_bf16 v36, v201, v3, v36
  v_dot2_f32_bf16 v36, v202, v4, v36
  v_dot2_f32_bf16 v36, v203, v5, v36
  s_waitcnt vmcnt(6)
  buffer_load_dwordx4 v[244:247], v1, s[44:47], s14 offen offset:1024 nt
  v_dot2_f32_bf16 v37, v204, v2, 0
  v_dot2_f32_bf16 v37, v205, v3, v37
  v_dot2_f32_bf16 v37, v206, v4, v37
  v_dot2_f32_bf16 v37, v207, v5, v37
  v_add_f32_dpp v39, v36, v36 row_ror:8 row_mask:0xf bank_mask:0x3
  s_nop 1
  v_add_f32_dpp v39, v37, v37 row_ror:8 row_mask:0xf bank_mask:0xc
  v_add_f32_dpp v40, v38, v38 row_shl:4 row_mask:0xf bank_mask:0x5
  s_nop 0
  v_add_f32_dpp v40, v39, v39 row_shr:4 row_mask:0xf bank_mask:0xa
  s_waitcnt vmcnt(6)
  buffer_load_dwordx4 v[248:251], v1, s[44:47], s14 offen offset:2048 nt
  v_dot2_f32_bf16 v36, v208, v2, 0
  v_dot2_f32_bf16 v36, v209, v3, v36
  v_dot2_f32_bf16 v36, v210, v4, v36
  v_dot2_f32_bf16 v36, v211, v5, v36
  s_waitcnt vmcnt(6)
  buffer_load_dwordx4 v[252:255], v1, s[44:47], s14 offen offset:3072 nt
  v_dot2_f32_bf16 v37, v212, v2, 0
  v_dot2_f32_bf16 v37, v213, v3, v37
  v_dot2_f32_bf16 v37, v214, v4, v37
  v_dot2_f32_bf16 v37, v215, v5, v37
  v_add_f32_dpp v38, v36, v36 row_ror:8 row_mask:0xf bank_mask:0x3
  s_nop 1
  v_add_f32_dpp v38, v37, v37 row_ror:8 row_mask:0xf bank_mask:0xc
  s_waitcnt vmcnt(6)
  s_add_u32 s14, s14, s15
  buffer_load_dwordx4 v[64:67], v1, s[44:47], s14 offen nt
  v_dot2_f32_bf16 v36, v216, v2, 0
  v_dot2_f32_bf16 v36, v217, v3, v36
  v_dot2_f32_bf16 v36, v218, v4, v36
  v_dot2_f32_bf16 v36, v219, v5, v36
  s_waitcnt vmcnt(6)
  buffer_load_dwordx4 v[68:71], v1, s[44:47], s14 offen offset:1024 nt
  v_dot2_f32_bf16 v37, v220, v2, 0
  v_dot2_f32_bf16 v37, v221, v3, v37
  v_dot2_f32_bf16 v37, v222, v4, v37
  v_dot2_f32_bf16 v37, v223, v5, v37
  v_add_f32_dpp v39, v36, v36 row_ror:8 row_mask:0xf bank_mask:0x3
  s_nop 1
  v_add_f32_dpp v39, v37, v37 row_ror:8 row_mask:0xf bank_mask:0xc
  v_add_f32_dpp v41, v38, v38 row_shl:4 row_mask:0xf bank_mask:0x5
  s_nop 0
  v_add_f32_dpp v41, v39, v39 row_shr:4 row_mask:0xf bank_mask:0xa
  v_cndmask_b32 v44, v40, v41, s[64:65]
  v_cndmask_b32 v45, v41, v40, s[64:65]
  s_nop 1
  v_add_f32_dpp v42, v45, v44 quad_perm:[1,0,3,2] row_mask:0xf bank_mask:0xf
  s_waitcnt vmcnt(6)
  buffer_load_dwordx4 v[72:75], v1, s[44:47], s14 offen offset:2048 nt
  v_dot2_f32_bf16 v36, v224, v2, 0
  v_dot2_f32_bf16 v36, v225, v3, v36
  v_dot2_f32_bf16 v36, v226, v4, v36
  v_dot2_f32_bf16 v36, v227, v5, v36
  s_waitcnt vmcnt(6)
  buffer_load_dwordx4 v[76:79], v1, s[44:47], s14 offen offset:3072 nt
  v_dot2_f32_bf16 v37, v228, v2, 0
  v_dot2_f32_bf16 v37, v229, v3, v37
  v_dot2_f32_bf16 v37, v230, v4, v37
  v_dot2_f32_bf16 v37, v231, v5, v37
  v_add_f32_dpp v38, v36, v36 row_ror:8 row_mask:0xf bank_mask:0x3
  s_nop 1
  v_add_f32_dpp v38, v37, v37 row_ror:8 row_mask:0xf bank_mask:0xc
  s_waitcnt vmcnt(6)
  s_add_u32 s14, s14, s15
  buffer_load_dwordx4 v[80:83], v1, s[44:47], s14 offen nt
  v_dot2_f32_bf16 v36, v232, v2, 0
  v_dot2_f32_bf16 v36, v233, v3, v36
  v_dot2_f32_bf16 v36, v234, v4, v36
  v_dot2_f32_bf16 v36, v235, v5, v36
  s_waitcnt vmcnt(6)
  buffer_load_dwordx4 v[84:87], v1, s[44:47], s14 offen offset:1024 nt
  v_dot2_f32_bf16 v37, v236, v2, 0
  v_dot2_f32_bf16 v37, v237, v3, v37
  v_dot2_f32_bf16 v37, v238, v4, v37
  v_dot2_f32_bf16 v37, v239, v5, v37
  v_add_f32_dpp v39, v36, v36 row_ror:8 row_mask:0xf bank_mask:0x3
  s_nop 1
  v_add_f32_dpp v39, v37, v37 row_ror:8 row_mask:0xf bank_mask:0xc
  v_add_f32_dpp v40, v38, v38 row_shl:4 row_mask:0xf bank_mask:0x5
  s_nop 0
  v_add_f32_dpp v40, v39, v39 row_shr:4 row_mask:0xf bank_mask:0xa
  v_cndmask_b32 v44, v40, v41, s[64:65]
  v_cndmask_b32 v45, v41, v40, s[64:65]
  s_nop 1
  v_add_f32_dpp v43, v45, v44 quad_perm:[1,0,3,2] row_mask:0xf bank_mask:0xf
  v_cndmask_b32 v44, v42, v43, s[66:67]
  v_cndmask_b32 v45, v43, v42, s[66:67]
  s_nop 1
  v_add_f32_dpp v20, v45, v44 quad_perm:[2,3,0,1] row_mask:0xf bank_mask:0xf
  v_cvt_pk_bf16_f32 v20, v20, v20
  v_and_b32 v20, 0xffff0000, v20
  v_mul_f32 v20, s68, v20
  v_cvt_pk_bf16_f32 v20, v20, v20
  v_and_b32 v20, 0xffff0000, v20
  buffer_load_dwordx4 v[88:91], v1, s[44:47], s14 offen offset:2048 nt
  buffer_load_dwordx4 v[92:95], v1, s[44:47], s14 offen offset:3072 nt
  v_mov_b32 v44, 0xff800000
  v_cndmask_b32 v20, v44, v20, s[60:61]
  v_max3_f32 v36, v10, v11, v12
  v_max3_f32 v37, v13, v14, v15
  v_max3_f32 v38, v16, v17, v18
  v_max3_f32 v36, v36, v19, v20
  v_max3_f32 v36, v36, v37, v38
  s_nop 1
  v_max_f32_dpp v36, v36, v36 row_ror:8 row_mask:0xf bank_mask:0xf
  s_nop 1
  v_max_f32_dpp v36, v36, v36 row_ror:4 row_mask:0xf bank_mask:0xf
  s_nop 1
  v_max_f32_dpp v36, v36, v36 row_ror:2 row_mask:0xf bank_mask:0xf
  s_nop 1
  v_max_f32_dpp v36, v36, v36 row_ror:1 row_mask:0xf bank_mask:0xf
  v_mov_b32 v38, v36
  s_nop 1
  v_permlane16_swap_b32 v36, v38
  v_max_f32 v36, v36, v38
  v_mov_b32 v38, v36
  s_nop 1
  v_permlane32_swap_b32 v36, v38
  v_max_f32 v36, v36, v38
  v_sub_f32 v10, v10, v36
  v_sub_f32 v11, v11, v36
  v_sub_f32 v12, v12, v36
  v_sub_f32 v13, v13, v36
  v_sub_f32 v14, v14, v36
  v_sub_f32 v15, v15, v36
  v_sub_f32 v16, v16, v36
  v_sub_f32 v17, v17, v36
  v_sub_f32 v18, v18, v36
  v_sub_f32 v19, v19, v36
  v_sub_f32 v20, v20, v36
  v_mul_f32 v10, s69, v10
  v_mul_f32 v11, s69, v11
  v_mul_f32 v12, s69, v12
  v_mul_f32 v13, s69, v13
  v_mul_f32 v14, s69, v14
  v_mul_f32 v15, s69, v15
  v_mul_f32 v16, s69, v16
  v_mul_f32 v17, s69, v17
  v_mul_f32 v18, s69, v18
  v_mul_f32 v19, s69, v19
  v_mul_f32 v20, s69, v20
  v_exp_f32 v10, v10
  v_exp_f32 v11, v11
  v_exp_f32 v12, v12
  v_exp_f32 v13, v13
  v_exp_f32 v14, v14
  v_exp_f32 v15, v15
  v_exp_f32 v16, v16
  v_exp_f32 v17, v17
  v_exp_f32 v18, v18
  v_exp_f32 v19, v19
  v_exp_f32 v20, v20
  v_add_f32 v37, v10, v11
  v_add_f32 v38, v12, v13
  v_add_f32 v37, v37, v14
  v_add_f32 v38, v38, v15
  v_add_f32 v37, v37, v16
  v_add_f32 v38, v38, v17
  v_add_f32 v37, v37, v38
  v_add_f32 v38, v18, v19
  v_add_f32 v37, v37, v20
  v_add_f32 v37, v37, v38
  v_cvt_pk_bf16_f32 v10, v10, v10
  v_cvt_pk_bf16_f32 v11, v11, v11
  v_cvt_pk_bf16_f32 v12, v12, v12
  v_cvt_pk_bf16_f32 v13, v13, v13
  v_cvt_pk_bf16_f32 v14, v14, v14
  v_cvt_pk_bf16_f32 v15, v15, v15
  v_cvt_pk_bf16_f32 v16, v16, v16
  v_cvt_pk_bf16_f32 v17, v17, v17
  v_cvt_pk_bf16_f32 v18, v18, v18
  v_cvt_pk_bf16_f32 v19, v19, v19
  v_cvt_pk_bf16_f32 v20, v20, v20
  v_add_f32_dpp v37, v37, v37 row_ror:8 row_mask:0xf bank_mask:0xf
  s_nop 1
  v_add_f32_dpp v37, v37, v37 row_ror:4 row_mask:0xf bank_mask:0xf
  s_nop 1
  v_add_f32_dpp v37, v37, v37 row_ror:2 row_mask:0xf bank_mask:0xf
  s_nop 1
  v_add_f32_dpp v37, v37, v37 row_ror:1 row_mask:0xf bank_mask:0xf
  v_mov_b32 v38, v37
  s_nop 1
  v_permlane16_swap_b32 v37, v38
  v_add_f32 v37, v37, v38
  v_mov_b32 v38, v37
  s_nop 1
  v_permlane32_swap_b32 v37, v38
  v_add_f32 v37, v37, v38
  v_min_u32 v36, -2, v36
  v_min_u32 v37, -2, v37
  ds_write_b64 v51, v[36:37] offset:256
  v_and_b32_dpp v28, v10, v6 row_newbcast:0 row_mask:0xf bank_mask:0xf
  v_and_b32_dpp v29, v10, v7 row_newbcast:0 row_mask:0xf bank_mask:0xf
  v_and_b32_dpp v30, v10, v8 row_newbcast:0 row_mask:0xf bank_mask:0xf
  v_and_b32_dpp v31, v10, v9 row_newbcast:0 row_mask:0xf bank_mask:0xf
  v_and_b32_dpp v32, v10, v6 row_newbcast:8 row_mask:0xf bank_mask:0xf
  v_and_b32_dpp v33, v10, v7 row_newbcast:8 row_mask:0xf bank_mask:0xf
  v_and_b32_dpp v34, v10, v8 row_newbcast:8 row_mask:0xf bank_mask:0xf
  v_and_b32_dpp v35, v10, v9 row_newbcast:8 row_mask:0xf bank_mask:0xf
  v_mfma_f32_16x16x32_bf16 v[24:27], v[28:31], v[240:243], 0
  v_and_b32_dpp v28, v10, v6 row_newbcast:4 row_mask:0xf bank_mask:0xf
  v_and_b32_dpp v29, v10, v7 row_newbcast:4 row_mask:0xf bank_mask:0xf
  v_and_b32_dpp v30, v10, v8 row_newbcast:4 row_mask:0xf bank_mask:0xf
  v_and_b32_dpp v31, v10, v9 row_newbcast:4 row_mask:0xf bank_mask:0xf
  v_mfma_f32_16x16x32_bf16 v[24:27], v[32:35], v[244:247], v[24:27]
  v_and_b32_dpp v32, v10, v6 row_newbcast:12 row_mask:0xf bank_mask:0xf
  v_and_b32_dpp v33, v10, v7 row_newbcast:12 row_mask:0xf bank_mask:0xf
  v_and_b32_dpp v34, v10, v8 row_newbcast:12 row_mask:0xf bank_mask:0xf
  v_and_b32_dpp v35, v10, v9 row_newbcast:12 row_mask:0xf bank_mask:0xf
  v_mfma_f32_16x16x32_bf16 v[24:27], v[28:31], v[248:251], v[24:27]
  v_and_b32_dpp v28, v10, v6 row_newbcast:1 row_mask:0xf bank_mask:0xf
  v_and_b32_dpp v29, v10, v7 row_newbcast:1 row_mask:0xf bank_mask:0xf
  v_and_b32_dpp v30, v10, v8 row_newbcast:1 row_mask:0xf bank_mask:0xf
  v_and_b32_dpp v31, v10, v9 row_newbcast:1 row_mask:0xf bank_mask:0xf
  s_waitcnt vmcnt(8)
  v_mfma_f32_16x16x32_bf16 v[24:27], v[32:35], v[252:255], v[24:27]
  v_and_b32_dpp v32, v10, v6 row_newbcast:9 row_mask:0xf bank_mask:0xf
  v_and_b32_dpp v33, v10, v7 row_newbcast:9 row_mask:0xf bank_mask:0xf
  v_and_b32_dpp v34, v10, v8 row_newbcast:9 row_mask:0xf bank_mask:0xf
  v_and_b32_dpp v35, v10, v9 row_newbcast:9 row_mask:0xf bank_mask:0xf
  s_waitcnt vmcnt(7)
  v_mfma_f32_16x16x32_bf16 v[24:27], v[28:31], v[64:67], v[24:27]
  v_and_b32_dpp v28, v10, v6 row_newbcast:5 row_mask:0xf bank_mask:0xf
  v_and_b32_dpp v29, v10, v7 row_newbcast:5 row_mask:0xf bank_mask:0xf
  v_and_b32_dpp v30, v10, v8 row_newbcast:5 row_mask:0xf bank_mask:0xf
  v_and_b32_dpp v31, v10, v9 row_newbcast:5 row_mask:0xf bank_mask:0xf
  s_waitcnt vmcnt(6)
  s_add_u32 s14, s14, s15
  buffer_load_dwordx4 v[96:99], v1, s[44:47], s14 offen nt
  v_mfma_f32_16x16x32_bf16 v[24:27], v[32:35], v[68:71], v[24:27]
  v_and_b32_dpp v32, v10, v6 row_newbcast:13 row_mask:0xf bank_mask:0xf
  v_and_b32_dpp v33, v10, v7 row_newbcast:13 row_mask:0xf bank_mask:0xf
  v_and_b32_dpp v34, v10, v8 row_newbcast:13 row_mask:0xf bank_mask:0xf
  v_and_b32_dpp v35, v10, v9 row_newbcast:13 row_mask:0xf bank_mask:0xf
  s_waitcnt vmcnt(6)
  buffer_load_dwordx4 v[100:103], v1, s[44:47], s14 offen offset:1024 nt
  v_mfma_f32_16x16x32_bf16 v[24:27], v[28:31], v[72:75], v[24:27]
  v_and_b32_dpp v28, v10, v6 row_newbcast:2 row_mask:0xf bank_mask:0xf
  v_and_b32_dpp v29, v10, v7 row_newbcast:2 row_mask:0xf bank_mask:0xf
  v_and_b32_dpp v30, v10, v8 row_newbcast:2 row_mask:0xf bank_mask:0xf
  v_and_b32_dpp v31, v10, v9 row_newbcast:2 row_mask:0xf bank_mask:0xf
  s_waitcnt vmcnt(6)
  buffer_load_dwordx4 v[104:107], v1, s[44:47], s14 offen offset:2048 nt
  v_mfma_f32_16x16x32_bf16 v[24:27], v[32:35], v[76:79], v[24:27]
  v_and_b32_dpp v32, v10, v6 row_newbcast:10 row_mask:0xf bank_mask:0xf
  v_and_b32_dpp v33, v10, v7 row_newbcast:10 row_mask:0xf bank_mask:0xf
  v_and_b32_dpp v34, v10, v8 row_newbcast:10 row_mask:0xf bank_mask:0xf
  v_and_b32_dpp v35, v10, v9 row_newbcast:10 row_mask:0xf bank_mask:0xf
  s_waitcnt vmcnt(6)
  buffer_load_dwordx4 v[108:111], v1, s[44:47], s14 offen offset:3072 nt
  v_mfma_f32_16x16x32_bf16 v[24:27], v[28:31], v[80:83], v[24:27]
  v_and_b32_dpp v28, v10, v6 row_newbcast:6 row_mask:0xf bank_mask:0xf
  v_and_b32_dpp v29, v10, v7 row_newbcast:6 row_mask:0xf bank_mask:0xf
  v_and_b32_dpp v30, v10, v8 row_newbcast:6 row_mask:0xf bank_mask:0xf
  v_and_b32_dpp v31, v10, v9 row_newbcast:6 row_mask:0xf bank_mask:0xf
  s_waitcnt vmcnt(6)
  s_add_u32 s14, s14, s15
  buffer_load_dwordx4 v[112:115], v1, s[44:47], s14 offen nt
  v_mfma_f32_16x16x32_bf16 v[24:27], v[32:35], v[84:87], v[24:27]
  v_and_b32_dpp v32, v10, v6 row_newbcast:14 row_mask:0xf bank_mask:0xf
  v_and_b32_dpp v33, v10, v7 row_newbcast:14 row_mask:0xf bank_mask:0xf
  v_and_b32_dpp v34, v10, v8 row_newbcast:14 row_mask:0xf bank_mask:0xf
  v_and_b32_dpp v35, v10, v9 row_newbcast:14 row_mask:0xf bank_mask:0xf
  s_waitcnt vmcnt(6)
  buffer_load_dwordx4 v[116:119], v1, s[44:47], s14 offen offset:1024 nt
  v_mfma_f32_16x16x32_bf16 v[24:27], v[28:31], v[88:91], v[24:27]
  v_and_b32_dpp v28, v10, v6 row_newbcast:3 row_mask:0xf bank_mask:0xf
  v_and_b32_dpp v29, v10, v7 row_newbcast:3 row_mask:0xf bank_mask:0xf
  v_and_b32_dpp v30, v10, v8 row_newbcast:3 row_mask:0xf bank_mask:0xf
  v_and_b32_dpp v31, v10, v9 row_newbcast:3 row_mask:0xf bank_mask:0xf
  s_waitcnt vmcnt(6)
  buffer_load_dwordx4 v[120:123], v1, s[44:47], s14 offen offset:2048 nt
  v_mfma_f32_16x16x32_bf16 v[24:27], v[32:35], v[92:95], v[24:27]
  v_and_b32_dpp v32, v10, v6 row_newbcast:11 row_mask:0xf bank_mask:0xf
  v_and_b32_dpp v33, v10, v7 row_newbcast:11 row_mask:0xf bank_mask:0xf
  v_and_b32_dpp v34, v10, v8 row_newbcast:11 row_mask:0xf bank_mask:0xf
  v_and_b32_dpp v35, v10, v9 row_newbcast:11 row_mask:0xf bank_mask:0xf
  s_waitcnt vmcnt(6)
  buffer_load_dwordx4 v[124:127], v1, s[44:47], s14 offen offset:3072 nt
  v_mfma_f32_16x16x32_bf16 v[24:27], v[28:31], v[96:99], v[24:27]
  v_and_b32_dpp v28, v10, v6 row_newbcast:7 row_mask:0xf bank_mask:0xf
  v_and_b32_dpp v29, v10, v7 row_newbcast:7 row_mask:0xf bank_mask:0xf
  v_and_b32_dpp v30, v10, v8 row_newbcast:7 row_mask:0xf bank_mask:0xf
  v_and_b32_dpp v31, v10, v9 row_newbcast:7 row_mask:0xf bank_mask:0xf
  s_waitcnt vmcnt(6)
  s_add_u32 s14, s14, s15
  buffer_load_dwordx4 v[128:131], v1, s[44:47], s14 offen nt
  v_mfma_f32_16x16x32_bf16 v[24:27], v[32:35], v[100:103], v[24:27]
  v_and_b32_dpp v32, v10, v6 row_newbcast:15 row_mask:0xf bank_mask:0xf
  v_and_b32_dpp v33, v10, v7 row_newbcast:15 row_mask:0xf bank_mask:0xf
  v_and_b32_dpp v34, v10, v8 row_newbcast:15 row_mask:0xf bank_mask:0xf
  v_and_b32_dpp v35, v10, v9 row_newbcast:15 row_mask:0xf bank_mask:0xf
  s_waitcnt vmcnt(6)
  buffer_load_dwordx4 v[132:135], v1, s[44:47], s14 offen offset:1024 nt
  v_mfma_f32_16x16x32_bf16 v[24:27], v[28:31], v[104:107], v[24:27]
  v_and_b32_dpp v28, v11, v6 row_newbcast:0 row_mask:0xf bank_mask:0xf
  v_and_b32_dpp v29, v11, v7 row_newbcast:0 row_mask:0xf bank_mask:0xf
  v_and_b32_dpp v30, v11, v8 row_newbcast:0 row_mask:0xf bank_mask:0xf
  v_and_b32_dpp v31, v11, v9 row_newbcast:0 row_mask:0xf bank_mask:0xf
  s_waitcnt vmcnt(6)
  buffer_load_dwordx4 v[136:139], v1, s[44:47], s14 offen offset:2048 nt
  v_mfma_f32_16x16x32_bf16 v[24:27], v[32:35], v[108:111], v[24:27]
  v_and_b32_dpp v32, v11, v6 row_newbcast:8 row_mask:0xf bank_mask:0xf
  v_and_b32_dpp v33, v11, v7 row_newbcast:8 row_mask:0xf bank_mask:0xf
  v_and_b32_dpp v34, v11, v8 row_newbcast:8 row_mask:0xf bank_mask:0xf
  v_and_b32_dpp v35, v11, v9 row_newbcast:8 row_mask:0xf bank_mask:0xf
  s_waitcnt vmcnt(6)
  buffer_load_dwordx4 v[140:143], v1, s[44:47], s14 offen offset:3072 nt
  v_mfma_f32_16x16x32_bf16 v[24:27], v[28:31], v[112:115], v[24:27]
  v_and_b32_dpp v28, v11, v6 row_newbcast:4 row_mask:0xf bank_mask:0xf
  v_and_b32_dpp v29, v11, v7 row_newbcast:4 row_mask:0xf bank_mask:0xf
  v_and_b32_dpp v30, v11, v8 row_newbcast:4 row_mask:0xf bank_mask:0xf
  v_and_b32_dpp v31, v11, v9 row_newbcast:4 row_mask:0xf bank_mask:0xf
  s_waitcnt vmcnt(6)
  s_add_u32 s14, s14, s15
  buffer_load_dwordx4 v[144:147], v1, s[44:47], s14 offen nt
  v_mfma_f32_16x16x32_bf16 v[24:27], v[32:35], v[116:119], v[24:27]
  v_and_b32_dpp v32, v11, v6 row_newbcast:12 row_mask:0xf bank_mask:0xf
  v_and_b32_dpp v33, v11, v7 row_newbcast:12 row_mask:0xf bank_mask:0xf
  v_and_b32_dpp v34, v11, v8 row_newbcast:12 row_mask:0xf bank_mask:0xf
  v_and_b32_dpp v35, v11, v9 row_newbcast:12 row_mask:0xf bank_mask:0xf
  s_waitcnt vmcnt(6)
  buffer_load_dwordx4 v[148:151], v1, s[44:47], s14 offen offset:1024 nt
  v_mfma_f32_16x16x32_bf16 v[24:27], v[28:31], v[120:123], v[24:27]
  v_and_b32_dpp v28, v11, v6 row_newbcast:1 row_mask:0xf bank_mask:0xf
  v_and_b32_dpp v29, v11, v7 row_newbcast:1 row_mask:0xf bank_mask:0xf
  v_and_b32_dpp v30, v11, v8 row_newbcast:1 row_mask:0xf bank_mask:0xf
  v_and_b32_dpp v31, v11, v9 row_newbcast:1 row_mask:0xf bank_mask:0xf
  s_waitcnt vmcnt(6)
  buffer_load_dwordx4 v[152:155], v1, s[44:47], s14 offen offset:2048 nt
  v_mfma_f32_16x16x32_bf16 v[24:27], v[32:35], v[124:127], v[24:27]
  v_and_b32_dpp v32, v11, v6 row_newbcast:9 row_mask:0xf bank_mask:0xf
  v_and_b32_dpp v33, v11, v7 row_newbcast:9 row_mask:0xf bank_mask:0xf
  v_and_b32_dpp v34, v11, v8 row_newbcast:9 row_mask:0xf bank_mask:0xf
  v_and_b32_dpp v35, v11, v9 row_newbcast:9 row_mask:0xf bank_mask:0xf
  s_waitcnt vmcnt(6)
  buffer_load_dwordx4 v[156:159], v1, s[44:47], s14 offen offset:3072 nt
  v_mfma_f32_16x16x32_bf16 v[24:27], v[28:31], v[128:131], v[24:27]
  v_and_b32_dpp v28, v11, v6 row_newbcast:5 row_mask:0xf bank_mask:0xf
  v_and_b32_dpp v29, v11, v7 row_newbcast:5 row_mask:0xf bank_mask:0xf
  v_and_b32_dpp v30, v11, v8 row_newbcast:5 row_mask:0xf bank_mask:0xf
  v_and_b32_dpp v31, v11, v9 row_newbcast:5 row_mask:0xf bank_mask:0xf
  s_waitcnt vmcnt(6)
  s_add_u32 s14, s14, s15
  buffer_load_dwordx4 v[160:163], v1, s[44:47], s14 offen nt
  v_mfma_f32_16x16x32_bf16 v[24:27], v[32:35], v[132:135], v[24:27]
  v_and_b32_dpp v32, v11, v6 row_newbcast:13 row_mask:0xf bank_mask:0xf
  v_and_b32_dpp v33, v11, v7 row_newbcast:13 row_mask:0xf bank_mask:0xf
  v_and_b32_dpp v34, v11, v8 row_newbcast:13 row_mask:0xf bank_mask:0xf
  v_and_b32_dpp v35, v11, v9 row_newbcast:13 row_mask:0xf bank_mask:0xf
  s_waitcnt vmcnt(6)
  buffer_load_dwordx4 v[164:167], v1, s[44:47], s14 offen offset:1024 nt
  v_mfma_f32_16x16x32_bf16 v[24:27], v[28:31], v[136:139], v[24:27]
  v_and_b32_dpp v28, v11, v6 row_newbcast:2 row_mask:0xf bank_mask:0xf
  v_and_b32_dpp v29, v11, v7 row_newbcast:2 row_mask:0xf bank_mask:0xf
  v_and_b32_dpp v30, v11, v8 row_newbcast:2 row_mask:0xf bank_mask:0xf
  v_and_b32_dpp v31, v11, v9 row_newbcast:2 row_mask:0xf bank_mask:0xf
  s_waitcnt vmcnt(6)
  buffer_load_dwordx4 v[168:171], v1, s[44:47], s14 offen offset:2048 nt
  v_mfma_f32_16x16x32_bf16 v[24:27], v[32:35], v[140:143], v[24:27]
  v_and_b32_dpp v32, v11, v6 row_newbcast:10 row_mask:0xf bank_mask:0xf
  v_and_b32_dpp v33, v11, v7 row_newbcast:10 row_mask:0xf bank_mask:0xf
  v_and_b32_dpp v34, v11, v8 row_newbcast:10 row_mask:0xf bank_mask:0xf
  v_and_b32_dpp v35, v11, v9 row_newbcast:10 row_mask:0xf bank_mask:0xf
  s_waitcnt vmcnt(6)
  buffer_load_dwordx4 v[172:175], v1, s[44:47], s14 offen offset:3072 nt
  v_mfma_f32_16x16x32_bf16 v[24:27], v[28:31], v[144:147], v[24:27]
  v_and_b32_dpp v28, v11, v6 row_newbcast:6 row_mask:0xf bank_mask:0xf
  v_and_b32_dpp v29, v11, v7 row_newbcast:6 row_mask:0xf bank_mask:0xf
  v_and_b32_dpp v30, v11, v8 row_newbcast:6 row_mask:0xf bank_mask:0xf
  v_and_b32_dpp v31, v11, v9 row_newbcast:6 row_mask:0xf bank_mask:0xf
  s_waitcnt vmcnt(6)
  s_add_u32 s14, s14, s15
  buffer_load_dwordx4 v[176:179], v1, s[44:47], s14 offen nt
  v_mfma_f32_16x16x32_bf16 v[24:27], v[32:35], v[148:151], v[24:27]
  v_and_b32_dpp v32, v11, v6 row_newbcast:14 row_mask:0xf bank_mask:0xf
  v_and_b32_dpp v33, v11, v7 row_newbcast:14 row_mask:0xf bank_mask:0xf
  v_and_b32_dpp v34, v11, v8 row_newbcast:14 row_mask:0xf bank_mask:0xf
  v_and_b32_dpp v35, v11, v9 row_newbcast:14 row_mask:0xf bank_mask:0xf
  s_waitcnt vmcnt(6)
  buffer_load_dwordx4 v[180:183], v1, s[44:47], s14 offen offset:1024 nt
  v_mfma_f32_16x16x32_bf16 v[24:27], v[28:31], v[152:155], v[24:27]
  v_and_b32_dpp v28, v11, v6 row_newbcast:3 row_mask:0xf bank_mask:0xf
  v_and_b32_dpp v29, v11, v7 row_newbcast:3 row_mask:0xf bank_mask:0xf
  v_and_b32_dpp v30, v11, v8 row_newbcast:3 row_mask:0xf bank_mask:0xf
  v_and_b32_dpp v31, v11, v9 row_newbcast:3 row_mask:0xf bank_mask:0xf
  s_waitcnt vmcnt(6)
  buffer_load_dwordx4 v[184:187], v1, s[44:47], s14 offen offset:2048 nt
  v_mfma_f32_16x16x32_bf16 v[24:27], v[32:35], v[156:159], v[24:27]
  v_and_b32_dpp v32, v11, v6 row_newbcast:11 row_mask:0xf bank_mask:0xf
  v_and_b32_dpp v33, v11, v7 row_newbcast:11 row_mask:0xf bank_mask:0xf
  v_and_b32_dpp v34, v11, v8 row_newbcast:11 row_mask:0xf bank_mask:0xf
  v_and_b32_dpp v35, v11, v9 row_newbcast:11 row_mask:0xf bank_mask:0xf
  s_waitcnt vmcnt(6)
  buffer_load_dwordx4 v[188:191], v1, s[44:47], s14 offen offset:3072 nt
  v_mfma_f32_16x16x32_bf16 v[24:27], v[28:31], v[160:163], v[24:27]
  v_and_b32_dpp v28, v11, v6 row_newbcast:7 row_mask:0xf bank_mask:0xf
  v_and_b32_dpp v29, v11, v7 row_newbcast:7 row_mask:0xf bank_mask:0xf
  v_and_b32_dpp v30, v11, v8 row_newbcast:7 row_mask:0xf bank_mask:0xf
  v_and_b32_dpp v31, v11, v9 row_newbcast:7 row_mask:0xf bank_mask:0xf
  s_waitcnt vmcnt(6)
  s_add_u32 s14, s14, s15
  buffer_load_dwordx4 v[192:195], v1, s[44:47], s14 offen nt
  v_mfma_f32_16x16x32_bf16 v[24:27], v[32:35], v[164:167], v[24:27]
  v_and_b32_dpp v32, v11, v6 row_newbcast:15 row_mask:0xf bank_mask:0xf
  v_and_b32_dpp v33, v11, v7 row_newbcast:15 row_mask:0xf bank_mask:0xf
  v_and_b32_dpp v34, v11, v8 row_newbcast:15 row_mask:0xf bank_mask:0xf
  v_and_b32_dpp v35, v11, v9 row_newbcast:15 row_mask:0xf bank_mask:0xf
  s_waitcnt vmcnt(6)
  buffer_load_dwordx4 v[196:199], v1, s[44:47], s14 offen offset:1024 nt
  v_mfma_f32_16x16x32_bf16 v[24:27], v[28:31], v[168:171], v[24:27]
  v_and_b32_dpp v28, v12, v6 row_newbcast:0 row_mask:0xf bank_mask:0xf
  v_and_b32_dpp v29, v12, v7 row_newbcast:0 row_mask:0xf bank_mask:0xf
  v_and_b32_dpp v30, v12, v8 row_newbcast:0 row_mask:0xf bank_mask:0xf
  v_and_b32_dpp v31, v12, v9 row_newbcast:0 row_mask:0xf bank_mask:0xf
  s_waitcnt vmcnt(6)
  buffer_load_dwordx4 v[200:203], v1, s[44:47], s14 offen offset:2048 nt
  v_mfma_f32_16x16x32_bf16 v[24:27], v[32:35], v[172:175], v[24:27]
  v_and_b32_dpp v32, v12, v6 row_newbcast:8 row_mask:0xf bank_mask:0xf
  v_and_b32_dpp v33, v12, v7 row_newbcast:8 row_mask:0xf bank_mask:0xf
  v_and_b32_dpp v34, v12, v8 row_newbcast:8 row_mask:0xf bank_mask:0xf
  v_and_b32_dpp v35, v12, v9 row_newbcast:8 row_mask:0xf bank_mask:0xf
  s_waitcnt vmcnt(6)
  buffer_load_dwordx4 v[204:207], v1, s[44:47], s14 offen offset:3072 nt
  v_mfma_f32_16x16x32_bf16 v[24:27], v[28:31], v[176:179], v[24:27]
  v_and_b32_dpp v28, v12, v6 row_newbcast:4 row_mask:0xf bank_mask:0xf
  v_and_b32_dpp v29, v12, v7 row_newbcast:4 row_mask:0xf bank_mask:0xf
  v_and_b32_dpp v30, v12, v8 row_newbcast:4 row_mask:0xf bank_mask:0xf
  v_and_b32_dpp v31, v12, v9 row_newbcast:4 row_mask:0xf bank_mask:0xf
  s_waitcnt vmcnt(6)
  s_add_u32 s14, s14, s15
  buffer_load_dwordx4 v[208:211], v1, s[44:47], s14 offen nt
  v_mfma_f32_16x16x32_bf16 v[24:27], v[32:35], v[180:183], v[24:27]
  v_and_b32_dpp v32, v12, v6 row_newbcast:12 row_mask:0xf bank_mask:0xf
  v_and_b32_dpp v33, v12, v7 row_newbcast:12 row_mask:0xf bank_mask:0xf
  v_and_b32_dpp v34, v12, v8 row_newbcast:12 row_mask:0xf bank_mask:0xf
  v_and_b32_dpp v35, v12, v9 row_newbcast:12 row_mask:0xf bank_mask:0xf
  s_waitcnt vmcnt(6)
  buffer_load_dwordx4 v[212:215], v1, s[44:47], s14 offen offset:1024 nt
  v_mfma_f32_16x16x32_bf16 v[24:27], v[28:31], v[184:187], v[24:27]
  v_and_b32_dpp v28, v12, v6 row_newbcast:1 row_mask:0xf bank_mask:0xf
  v_and_b32_dpp v29, v12, v7 row_newbcast:1 row_mask:0xf bank_mask:0xf
  v_and_b32_dpp v30, v12, v8 row_newbcast:1 row_mask:0xf bank_mask:0xf
  v_and_b32_dpp v31, v12, v9 row_newbcast:1 row_mask:0xf bank_mask:0xf
  s_waitcnt vmcnt(6)
  buffer_load_dwordx4 v[216:219], v1, s[44:47], s14 offen offset:2048 nt
  v_mfma_f32_16x16x32_bf16 v[24:27], v[32:35], v[188:191], v[24:27]
  v_and_b32_dpp v32, v12, v6 row_newbcast:9 row_mask:0xf bank_mask:0xf
  v_and_b32_dpp v33, v12, v7 row_newbcast:9 row_mask:0xf bank_mask:0xf
  v_and_b32_dpp v34, v12, v8 row_newbcast:9 row_mask:0xf bank_mask:0xf
  v_and_b32_dpp v35, v12, v9 row_newbcast:9 row_mask:0xf bank_mask:0xf
  s_waitcnt vmcnt(6)
  buffer_load_dwordx4 v[220:223], v1, s[44:47], s14 offen offset:3072 nt
  v_mfma_f32_16x16x32_bf16 v[24:27], v[28:31], v[192:195], v[24:27]
  v_and_b32_dpp v28, v12, v6 row_newbcast:5 row_mask:0xf bank_mask:0xf
  v_and_b32_dpp v29, v12, v7 row_newbcast:5 row_mask:0xf bank_mask:0xf
  v_and_b32_dpp v30, v12, v8 row_newbcast:5 row_mask:0xf bank_mask:0xf
  v_and_b32_dpp v31, v12, v9 row_newbcast:5 row_mask:0xf bank_mask:0xf
  s_waitcnt vmcnt(6)
  s_add_u32 s14, s14, s15
  buffer_load_dwordx4 v[224:227], v1, s[44:47], s14 offen nt
  v_mfma_f32_16x16x32_bf16 v[24:27], v[32:35], v[196:199], v[24:27]
  v_and_b32_dpp v32, v12, v6 row_newbcast:13 row_mask:0xf bank_mask:0xf
  v_and_b32_dpp v33, v12, v7 row_newbcast:13 row_mask:0xf bank_mask:0xf
  v_and_b32_dpp v34, v12, v8 row_newbcast:13 row_mask:0xf bank_mask:0xf
  v_and_b32_dpp v35, v12, v9 row_newbcast:13 row_mask:0xf bank_mask:0xf
  s_waitcnt vmcnt(6)
  buffer_load_dwordx4 v[228:231], v1, s[44:47], s14 offen offset:1024 nt
  v_mfma_f32_16x16x32_bf16 v[24:27], v[28:31], v[200:203], v[24:27]
  v_and_b32_dpp v28, v12, v6 row_newbcast:2 row_mask:0xf bank_mask:0xf
  v_and_b32_dpp v29, v12, v7 row_newbcast:2 row_mask:0xf bank_mask:0xf
  v_and_b32_dpp v30, v12, v8 row_newbcast:2 row_mask:0xf bank_mask:0xf
  v_and_b32_dpp v31, v12, v9 row_newbcast:2 row_mask:0xf bank_mask:0xf
  s_waitcnt vmcnt(6)
  buffer_load_dwordx4 v[232:235], v1, s[44:47], s14 offen offset:2048 nt
  v_mfma_f32_16x16x32_bf16 v[24:27], v[32:35], v[204:207], v[24:27]
  v_and_b32_dpp v32, v12, v6 row_newbcast:10 row_mask:0xf bank_mask:0xf
  v_and_b32_dpp v33, v12, v7 row_newbcast:10 row_mask:0xf bank_mask:0xf
  v_and_b32_dpp v34, v12, v8 row_newbcast:10 row_mask:0xf bank_mask:0xf
  v_and_b32_dpp v35, v12, v9 row_newbcast:10 row_mask:0xf bank_mask:0xf
  s_waitcnt vmcnt(6)
  buffer_load_dwordx4 v[236:239], v1, s[44:47], s14 offen offset:3072 nt
  v_mfma_f32_16x16x32_bf16 v[24:27], v[28:31], v[208:211], v[24:27]
  v_and_b32_dpp v28, v12, v6 row_newbcast:6 row_mask:0xf bank_mask:0xf
  v_and_b32_dpp v29, v12, v7 row_newbcast:6 row_mask:0xf bank_mask:0xf
  v_and_b32_dpp v30, v12, v8 row_newbcast:6 row_mask:0xf bank_mask:0xf
  v_and_b32_dpp v31, v12, v9 row_newbcast:6 row_mask:0xf bank_mask:0xf
  s_waitcnt vmcnt(6)
  s_add_u32 s14, s14, s15
  buffer_load_dwordx4 v[240:243], v1, s[44:47], s14 offen nt
  v_mfma_f32_16x16x32_bf16 v[24:27], v[32:35], v[212:215], v[24:27]
  v_and_b32_dpp v32, v12, v6 row_newbcast:14 row_mask:0xf bank_mask:0xf
  v_and_b32_dpp v33, v12, v7 row_newbcast:14 row_mask:0xf bank_mask:0xf
  v_and_b32_dpp v34, v12, v8 row_newbcast:14 row_mask:0xf bank_mask:0xf
  v_and_b32_dpp v35, v12, v9 row_newbcast:14 row_mask:0xf bank_mask:0xf
  s_waitcnt vmcnt(6)
  buffer_load_dwordx4 v[244:247], v1, s[44:47], s14 offen offset:1024 nt
  v_mfma_f32_16x16x32_bf16 v[24:27], v[28:31], v[216:219], v[24:27]
  v_and_b32_dpp v28, v12, v6 row_newbcast:3 row_mask:0xf bank_mask:0xf
  v_and_b32_dpp v29, v12, v7 row_newbcast:3 row_mask:0xf bank_mask:0xf
  v_and_b32_dpp v30, v12, v8 row_newbcast:3 row_mask:0xf bank_mask:0xf
  v_and_b32_dpp v31, v12, v9 row_newbcast:3 row_mask:0xf bank_mask:0xf
  s_waitcnt vmcnt(6)
  buffer_load_dwordx4 v[248:251], v1, s[44:47], s14 offen offset:2048 nt
  v_mfma_f32_16x16x32_bf16 v[24:27], v[32:35], v[220:223], v[24:27]
  v_and_b32_dpp v32, v12, v6 row_newbcast:11 row_mask:0xf bank_mask:0xf
  v_and_b32_dpp v33, v12, v7 row_newbcast:11 row_mask:0xf bank_mask:0xf
  v_and_b32_dpp v34, v12, v8 row_newbcast:11 row_mask:0xf bank_mask:0xf
  v_and_b32_dpp v35, v12, v9 row_newbcast:11 row_mask:0xf bank_mask:0xf
  s_waitcnt vmcnt(6)
  buffer_load_dwordx4 v[252:255], v1, s[44:47], s14 offen offset:3072 nt
  v_mfma_f32_16x16x32_bf16 v[24:27], v[28:31], v[224:227], v[24:27]
  v_and_b32_dpp v28, v12, v6 row_newbcast:7 row_mask:0xf bank_mask:0xf
  v_and_b32_dpp v29, v12, v7 row_newbcast:7 row_mask:0xf bank_mask:0xf
  v_and_b32_dpp v30, v12, v8 row_newbcast:7 row_mask:0xf bank_mask:0xf
  v_and_b32_dpp v31, v12, v9 row_newbcast:7 row_mask:0xf bank_mask:0xf
  s_waitcnt vmcnt(6)
  s_add_u32 s14, s14, s15
  buffer_load_dwordx4 v[64:67], v1, s[44:47], s14 offen nt
  v_mfma_f32_16x16x32_bf16 v[24:27], v[32:35], v[228:231], v[24:27]
  v_and_b32_dpp v32, v12, v6 row_newbcast:15 row_mask:0xf bank_mask:0xf
  v_and_b32_dpp v33, v12, v7 row_newbcast:15 row_mask:0xf bank_mask:0xf
  v_and_b32_dpp v34, v12, v8 row_newbcast:15 row_mask:0xf bank_mask:0xf
  v_and_b32_dpp v35, v12, v9 row_newbcast:15 row_mask:0xf bank_mask:0xf
  s_waitcnt vmcnt(6)
  buffer_load_dwordx4 v[68:71], v1, s[44:47], s14 offen offset:1024 nt
  v_mfma_f32_16x16x32_bf16 v[24:27], v[28:31], v[232:235], v[24:27]
  v_and_b32_dpp v28, v13, v6 row_newbcast:0 row_mask:0xf bank_mask:0xf
  v_and_b32_dpp v29, v13, v7 row_newbcast:0 row_mask:0xf bank_mask:0xf
  v_and_b32_dpp v30, v13, v8 row_newbcast:0 row_mask:0xf bank_mask:0xf
  v_and_b32_dpp v31, v13, v9 row_newbcast:0 row_mask:0xf bank_mask:0xf
  s_waitcnt vmcnt(6)
  buffer_load_dwordx4 v[72:75], v1, s[44:47], s14 offen offset:2048 nt
  v_mfma_f32_16x16x32_bf16 v[24:27], v[32:35], v[236:239], v[24:27]
  v_and_b32_dpp v32, v13, v6 row_newbcast:8 row_mask:0xf bank_mask:0xf
  v_and_b32_dpp v33, v13, v7 row_newbcast:8 row_mask:0xf bank_mask:0xf
  v_and_b32_dpp v34, v13, v8 row_newbcast:8 row_mask:0xf bank_mask:0xf
  v_and_b32_dpp v35, v13, v9 row_newbcast:8 row_mask:0xf bank_mask:0xf
  s_waitcnt vmcnt(6)
  buffer_load_dwordx4 v[76:79], v1, s[44:47], s14 offen offset:3072 nt
  v_mfma_f32_16x16x32_bf16 v[24:27], v[28:31], v[240:243], v[24:27]
  v_and_b32_dpp v28, v13, v6 row_newbcast:4 row_mask:0xf bank_mask:0xf
  v_and_b32_dpp v29, v13, v7 row_newbcast:4 row_mask:0xf bank_mask:0xf
  v_and_b32_dpp v30, v13, v8 row_newbcast:4 row_mask:0xf bank_mask:0xf
  v_and_b32_dpp v31, v13, v9 row_newbcast:4 row_mask:0xf bank_mask:0xf
  s_waitcnt vmcnt(6)
  s_add_u32 s14, s14, s15
  buffer_load_dwordx4 v[80:83], v1, s[44:47], s14 offen nt
  v_mfma_f32_16x16x32_bf16 v[24:27], v[32:35], v[244:247], v[24:27]
  v_and_b32_dpp v32, v13, v6 row_newbcast:12 row_mask:0xf bank_mask:0xf
  v_and_b32_dpp v33, v13, v7 row_newbcast:12 row_mask:0xf bank_mask:0xf
  v_and_b32_dpp v34, v13, v8 row_newbcast:12 row_mask:0xf bank_mask:0xf
  v_and_b32_dpp v35, v13, v9 row_newbcast:12 row_mask:0xf bank_mask:0xf
  s_waitcnt vmcnt(6)
  buffer_load_dwordx4 v[84:87], v1, s[44:47], s14 offen offset:1024 nt
  v_mfma_f32_16x16x32_bf16 v[24:27], v[28:31], v[248:251], v[24:27]
  v_and_b32_dpp v28, v13, v6 row_newbcast:1 row_mask:0xf bank_mask:0xf
  v_and_b32_dpp v29, v13, v7 row_newbcast:1 row_mask:0xf bank_mask:0xf
  v_and_b32_dpp v30, v13, v8 row_newbcast:1 row_mask:0xf bank_mask:0xf
  v_and_b32_dpp v31, v13, v9 row_newbcast:1 row_mask:0xf bank_mask:0xf
  s_waitcnt vmcnt(6)
  buffer_load_dwordx4 v[88:91], v1, s[44:47], s14 offen offset:2048 nt
  v_mfma_f32_16x16x32_bf16 v[24:27], v[32:35], v[252:255], v[24:27]
  v_and_b32_dpp v32, v13, v6 row_newbcast:9 row_mask:0xf bank_mask:0xf
  v_and_b32_dpp v33, v13, v7 row_newbcast:9 row_mask:0xf bank_mask:0xf
  v_and_b32_dpp v34, v13, v8 row_newbcast:9 row_mask:0xf bank_mask:0xf
  v_and_b32_dpp v35, v13, v9 row_newbcast:9 row_mask:0xf bank_mask:0xf
  s_waitcnt vmcnt(6)
  buffer_load_dwordx4 v[92:95], v1, s[44:47], s14 offen offset:3072 nt
  v_mfma_f32_16x16x32_bf16 v[24:27], v[28:31], v[64:67], v[24:27]
  v_and_b32_dpp v28, v13, v6 row_newbcast:5 row_mask:0xf bank_mask:0xf
  v_and_b32_dpp v29, v13, v7 row_newbcast:5 row_mask:0xf bank_mask:0xf
  v_and_b32_dpp v30, v13, v8 row_newbcast:5 row_mask:0xf bank_mask:0xf
  v_and_b32_dpp v31, v13, v9 row_newbcast:5 row_mask:0xf bank_mask:0xf
  s_waitcnt vmcnt(6)
  s_add_u32 s14, s14, s15
  buffer_load_dwordx4 v[96:99], v1, s[44:47], s14 offen nt
  v_mfma_f32_16x16x32_bf16 v[24:27], v[32:35], v[68:71], v[24:27]
  v_and_b32_dpp v32, v13, v6 row_newbcast:13 row_mask:0xf bank_mask:0xf
  v_and_b32_dpp v33, v13, v7 row_newbcast:13 row_mask:0xf bank_mask:0xf
  v_and_b32_dpp v34, v13, v8 row_newbcast:13 row_mask:0xf bank_mask:0xf
  v_and_b32_dpp v35, v13, v9 row_newbcast:13 row_mask:0xf bank_mask:0xf
  s_waitcnt vmcnt(6)
  buffer_load_dwordx4 v[100:103], v1, s[44:47], s14 offen offset:1024 nt
  v_mfma_f32_16x16x32_bf16 v[24:27], v[28:31], v[72:75], v[24:27]
  v_and_b32_dpp v28, v13, v6 row_newbcast:2 row_mask:0xf bank_mask:0xf
  v_and_b32_dpp v29, v13, v7 row_newbcast:2 row_mask:0xf bank_mask:0xf
  v_and_b32_dpp v30, v13, v8 row_newbcast:2 row_mask:0xf bank_mask:0xf
  v_and_b32_dpp v31, v13, v9 row_newbcast:2 row_mask:0xf bank_mask:0xf
  s_waitcnt vmcnt(6)
  buffer_load_dwordx4 v[104:107], v1, s[44:47], s14 offen offset:2048 nt
  v_mfma_f32_16x16x32_bf16 v[24:27], v[32:35], v[76:79], v[24:27]
  v_and_b32_dpp v32, v13, v6 row_newbcast:10 row_mask:0xf bank_mask:0xf
  v_and_b32_dpp v33, v13, v7 row_newbcast:10 row_mask:0xf bank_mask:0xf
  v_and_b32_dpp v34, v13, v8 row_newbcast:10 row_mask:0xf bank_mask:0xf
  v_and_b32_dpp v35, v13, v9 row_newbcast:10 row_mask:0xf bank_mask:0xf
  s_waitcnt vmcnt(6)
  buffer_load_dwordx4 v[108:111], v1, s[44:47], s14 offen offset:3072 nt
  v_mfma_f32_16x16x32_bf16 v[24:27], v[28:31], v[80:83], v[24:27]
  v_and_b32_dpp v28, v13, v6 row_newbcast:6 row_mask:0xf bank_mask:0xf
  v_and_b32_dpp v29, v13, v7 row_newbcast:6 row_mask:0xf bank_mask:0xf
  v_and_b32_dpp v30, v13, v8 row_newbcast:6 row_mask:0xf bank_mask:0xf
  v_and_b32_dpp v31, v13, v9 row_newbcast:6 row_mask:0xf bank_mask:0xf
  s_waitcnt vmcnt(6)
  s_add_u32 s14, s14, s15
  buffer_load_dwordx4 v[112:115], v1, s[44:47], s14 offen nt
  v_mfma_f32_16x16x32_bf16 v[24:27], v[32:35], v[84:87], v[24:27]
  v_and_b32_dpp v32, v13, v6 row_newbcast:14 row_mask:0xf bank_mask:0xf
  v_and_b32_dpp v33, v13, v7 row_newbcast:14 row_mask:0xf bank_mask:0xf
  v_and_b32_dpp v34, v13, v8 row_newbcast:14 row_mask:0xf bank_mask:0xf
  v_and_b32_dpp v35, v13, v9 row_newbcast:14 row_mask:0xf bank_mask:0xf
  s_waitcnt vmcnt(6)
  buffer_load_dwordx4 v[116:119], v1, s[44:47], s14 offen offset:1024 nt
  v_mfma_f32_16x16x32_bf16 v[24:27], v[28:31], v[88:91], v[24:27]
  v_and_b32_dpp v28, v13, v6 row_newbcast:3 row_mask:0xf bank_mask:0xf
  v_and_b32_dpp v29, v13, v7 row_newbcast:3 row_mask:0xf bank_mask:0xf
  v_and_b32_dpp v30, v13, v8 row_newbcast:3 row_mask:0xf bank_mask:0xf
  v_and_b32_dpp v31, v13, v9 row_newbcast:3 row_mask:0xf bank_mask:0xf
  s_waitcnt vmcnt(6)
  buffer_load_dwordx4 v[120:123], v1, s[44:47], s14 offen offset:2048 nt
  v_mfma_f32_16x16x32_bf16 v[24:27], v[32:35], v[92:95], v[24:27]
  v_and_b32_dpp v32, v13, v6 row_newbcast:11 row_mask:0xf bank_mask:0xf
  v_and_b32_dpp v33, v13, v7 row_newbcast:11 row_mask:0xf bank_mask:0xf
  v_and_b32_dpp v34, v13, v8 row_newbcast:11 row_mask:0xf bank_mask:0xf
  v_and_b32_dpp v35, v13, v9 row_newbcast:11 row_mask:0xf bank_mask:0xf
  s_waitcnt vmcnt(6)
  buffer_load_dwordx4 v[124:127], v1, s[44:47], s14 offen offset:3072 nt
  v_mfma_f32_16x16x32_bf16 v[24:27], v[28:31], v[96:99], v[24:27]
  v_and_b32_dpp v28, v13, v6 row_newbcast:7 row_mask:0xf bank_mask:0xf
  v_and_b32_dpp v29, v13, v7 row_newbcast:7 row_mask:0xf bank_mask:0xf
  v_and_b32_dpp v30, v13, v8 row_newbcast:7 row_mask:0xf bank_mask:0xf
  v_and_b32_dpp v31, v13, v9 row_newbcast:7 row_mask:0xf bank_mask:0xf
  s_waitcnt vmcnt(6)
  s_add_u32 s14, s14, s15
  buffer_load_dwordx4 v[128:131], v1, s[44:47], s14 offen nt
  v_mfma_f32_16x16x32_bf16 v[24:27], v[32:35], v[100:103], v[24:27]
  v_and_b32_dpp v32, v13, v6 row_newbcast:15 row_mask:0xf bank_mask:0xf
  v_and_b32_dpp v33, v13, v7 row_newbcast:15 row_mask:0xf bank_mask:0xf
  v_and_b32_dpp v34, v13, v8 row_newbcast:15 row_mask:0xf bank_mask:0xf
  v_and_b32_dpp v35, v13, v9 row_newbcast:15 row_mask:0xf bank_mask:0xf
  s_waitcnt vmcnt(6)
  buffer_load_dwordx4 v[132:135], v1, s[44:47], s14 offen offset:1024 nt
  v_mfma_f32_16x16x32_bf16 v[24:27], v[28:31], v[104:107], v[24:27]
  v_and_b32_dpp v28, v14, v6 row_newbcast:0 row_mask:0xf bank_mask:0xf
  v_and_b32_dpp v29, v14, v7 row_newbcast:0 row_mask:0xf bank_mask:0xf
  v_and_b32_dpp v30, v14, v8 row_newbcast:0 row_mask:0xf bank_mask:0xf
  v_and_b32_dpp v31, v14, v9 row_newbcast:0 row_mask:0xf bank_mask:0xf
  s_waitcnt vmcnt(6)
  buffer_load_dwordx4 v[136:139], v1, s[44:47], s14 offen offset:2048 nt
  v_mfma_f32_16x16x32_bf16 v[24:27], v[32:35], v[108:111], v[24:27]
  v_and_b32_dpp v32, v14, v6 row_newbcast:8 row_mask:0xf bank_mask:0xf
  v_and_b32_dpp v33, v14, v7 row_newbcast:8 row_mask:0xf bank_mask:0xf
  v_and_b32_dpp v34, v14, v8 row_newbcast:8 row_mask:0xf bank_mask:0xf
  v_and_b32_dpp v35, v14, v9 row_newbcast:8 row_mask:0xf bank_mask:0xf
  s_waitcnt vmcnt(6)
  buffer_load_dwordx4 v[140:143], v1, s[44:47], s14 offen offset:3072 nt
  v_mfma_f32_16x16x32_bf16 v[24:27], v[28:31], v[112:115], v[24:27]
  v_and_b32_dpp v28, v14, v6 row_newbcast:4 row_mask:0xf bank_mask:0xf
  v_and_b32_dpp v29, v14, v7 row_newbcast:4 row_mask:0xf bank_mask:0xf
  v_and_b32_dpp v30, v14, v8 row_newbcast:4 row_mask:0xf bank_mask:0xf
  v_and_b32_dpp v31, v14, v9 row_newbcast:4 row_mask:0xf bank_mask:0xf
  s_waitcnt vmcnt(6)
  s_add_u32 s14, s14, s15
  buffer_load_dwordx4 v[144:147], v1, s[44:47], s14 offen nt
  v_mfma_f32_16x16x32_bf16 v[24:27], v[32:35], v[116:119], v[24:27]
  v_and_b32_dpp v32, v14, v6 row_newbcast:12 row_mask:0xf bank_mask:0xf
  v_and_b32_dpp v33, v14, v7 row_newbcast:12 row_mask:0xf bank_mask:0xf
  v_and_b32_dpp v34, v14, v8 row_newbcast:12 row_mask:0xf bank_mask:0xf
  v_and_b32_dpp v35, v14, v9 row_newbcast:12 row_mask:0xf bank_mask:0xf
  s_waitcnt vmcnt(6)
  buffer_load_dwordx4 v[148:151], v1, s[44:47], s14 offen offset:1024 nt
  v_mfma_f32_16x16x32_bf16 v[24:27], v[28:31], v[120:123], v[24:27]
  v_and_b32_dpp v28, v14, v6 row_newbcast:1 row_mask:0xf bank_mask:0xf
  v_and_b32_dpp v29, v14, v7 row_newbcast:1 row_mask:0xf bank_mask:0xf
  v_and_b32_dpp v30, v14, v8 row_newbcast:1 row_mask:0xf bank_mask:0xf
  v_and_b32_dpp v31, v14, v9 row_newbcast:1 row_mask:0xf bank_mask:0xf
  s_waitcnt vmcnt(6)
  buffer_load_dwordx4 v[152:155], v1, s[44:47], s14 offen offset:2048 nt
  v_mfma_f32_16x16x32_bf16 v[24:27], v[32:35], v[124:127], v[24:27]
  v_and_b32_dpp v32, v14, v6 row_newbcast:9 row_mask:0xf bank_mask:0xf
  v_and_b32_dpp v33, v14, v7 row_newbcast:9 row_mask:0xf bank_mask:0xf
  v_and_b32_dpp v34, v14, v8 row_newbcast:9 row_mask:0xf bank_mask:0xf
  v_and_b32_dpp v35, v14, v9 row_newbcast:9 row_mask:0xf bank_mask:0xf
  s_waitcnt vmcnt(6)
  buffer_load_dwordx4 v[156:159], v1, s[44:47], s14 offen offset:3072 nt
  v_mfma_f32_16x16x32_bf16 v[24:27], v[28:31], v[128:131], v[24:27]
  v_and_b32_dpp v28, v14, v6 row_newbcast:5 row_mask:0xf bank_mask:0xf
  v_and_b32_dpp v29, v14, v7 row_newbcast:5 row_mask:0xf bank_mask:0xf
  v_and_b32_dpp v30, v14, v8 row_newbcast:5 row_mask:0xf bank_mask:0xf
  v_and_b32_dpp v31, v14, v9 row_newbcast:5 row_mask:0xf bank_mask:0xf
  s_waitcnt vmcnt(6)
  s_add_u32 s14, s14, s15
  buffer_load_dwordx4 v[160:163], v1, s[44:47], s14 offen nt
  v_mfma_f32_16x16x32_bf16 v[24:27], v[32:35], v[132:135], v[24:27]
  v_and_b32_dpp v32, v14, v6 row_newbcast:13 row_mask:0xf bank_mask:0xf
  v_and_b32_dpp v33, v14, v7 row_newbcast:13 row_mask:0xf bank_mask:0xf
  v_and_b32_dpp v34, v14, v8 row_newbcast:13 row_mask:0xf bank_mask:0xf
  v_and_b32_dpp v35, v14, v9 row_newbcast:13 row_mask:0xf bank_mask:0xf
  s_waitcnt vmcnt(6)
  buffer_load_dwordx4 v[164:167], v1, s[44:47], s14 offen offset:1024 nt
  v_mfma_f32_16x16x32_bf16 v[24:27], v[28:31], v[136:139], v[24:27]
  v_and_b32_dpp v28, v14, v6 row_newbcast:2 row_mask:0xf bank_mask:0xf
  v_and_b32_dpp v29, v14, v7 row_newbcast:2 row_mask:0xf bank_mask:0xf
  v_and_b32_dpp v30, v14, v8 row_newbcast:2 row_mask:0xf bank_mask:0xf
  v_and_b32_dpp v31, v14, v9 row_newbcast:2 row_mask:0xf bank_mask:0xf
  s_waitcnt vmcnt(6)
  buffer_load_dwordx4 v[168:171], v1, s[44:47], s14 offen offset:2048 nt
  v_mfma_f32_16x16x32_bf16 v[24:27], v[32:35], v[140:143], v[24:27]
  v_and_b32_dpp v32, v14, v6 row_newbcast:10 row_mask:0xf bank_mask:0xf
  v_and_b32_dpp v33, v14, v7 row_newbcast:10 row_mask:0xf bank_mask:0xf
  v_and_b32_dpp v34, v14, v8 row_newbcast:10 row_mask:0xf bank_mask:0xf
  v_and_b32_dpp v35, v14, v9 row_newbcast:10 row_mask:0xf bank_mask:0xf
  s_waitcnt vmcnt(6)
  buffer_load_dwordx4 v[172:175], v1, s[44:47], s14 offen offset:3072 nt
  v_mfma_f32_16x16x32_bf16 v[24:27], v[28:31], v[144:147], v[24:27]
  v_and_b32_dpp v28, v14, v6 row_newbcast:6 row_mask:0xf bank_mask:0xf
  v_and_b32_dpp v29, v14, v7 row_newbcast:6 row_mask:0xf bank_mask:0xf
  v_and_b32_dpp v30, v14, v8 row_newbcast:6 row_mask:0xf bank_mask:0xf
  v_and_b32_dpp v31, v14, v9 row_newbcast:6 row_mask:0xf bank_mask:0xf
  s_waitcnt vmcnt(6)
  s_add_u32 s14, s14, s15
  buffer_load_dwordx4 v[176:179], v1, s[44:47], s14 offen nt
  v_mfma_f32_16x16x32_bf16 v[24:27], v[32:35], v[148:151], v[24:27]
  v_and_b32_dpp v32, v14, v6 row_newbcast:14 row_mask:0xf bank_mask:0xf
  v_and_b32_dpp v33, v14, v7 row_newbcast:14 row_mask:0xf bank_mask:0xf
  v_and_b32_dpp v34, v14, v8 row_newbcast:14 row_mask:0xf bank_mask:0xf
  v_and_b32_dpp v35, v14, v9 row_newbcast:14 row_mask:0xf bank_mask:0xf
  s_waitcnt vmcnt(6)
  buffer_load_dwordx4 v[180:183], v1, s[44:47], s14 offen offset:1024 nt
  v_mfma_f32_16x16x32_bf16 v[24:27], v[28:31], v[152:155], v[24:27]
  v_and_b32_dpp v28, v14, v6 row_newbcast:3 row_mask:0xf bank_mask:0xf
  v_and_b32_dpp v29, v14, v7 row_newbcast:3 row_mask:0xf bank_mask:0xf
  v_and_b32_dpp v30, v14, v8 row_newbcast:3 row_mask:0xf bank_mask:0xf
  v_and_b32_dpp v31, v14, v9 row_newbcast:3 row_mask:0xf bank_mask:0xf
  s_waitcnt vmcnt(6)
  buffer_load_dwordx4 v[184:187], v1, s[44:47], s14 offen offset:2048 nt
  v_mfma_f32_16x16x32_bf16 v[24:27], v[32:35], v[156:159], v[24:27]
  v_and_b32_dpp v32, v14, v6 row_newbcast:11 row_mask:0xf bank_mask:0xf
  v_and_b32_dpp v33, v14, v7 row_newbcast:11 row_mask:0xf bank_mask:0xf
  v_and_b32_dpp v34, v14, v8 row_newbcast:11 row_mask:0xf bank_mask:0xf
  v_and_b32_dpp v35, v14, v9 row_newbcast:11 row_mask:0xf bank_mask:0xf
  s_waitcnt vmcnt(6)
  buffer_load_dwordx4 v[188:191], v1, s[44:47], s14 offen offset:3072 nt
  v_mfma_f32_16x16x32_bf16 v[24:27], v[28:31], v[160:163], v[24:27]
  v_and_b32_dpp v28, v14, v6 row_newbcast:7 row_mask:0xf bank_mask:0xf
  v_and_b32_dpp v29, v14, v7 row_newbcast:7 row_mask:0xf bank_mask:0xf
  v_and_b32_dpp v30, v14, v8 row_newbcast:7 row_mask:0xf bank_mask:0xf
  v_and_b32_dpp v31, v14, v9 row_newbcast:7 row_mask:0xf bank_mask:0xf
  s_waitcnt vmcnt(6)
  s_add_u32 s14, s14, s15
  buffer_load_dwordx4 v[192:195], v1, s[44:47], s14 offen nt
  v_mfma_f32_16x16x32_bf16 v[24:27], v[32:35], v[164:167], v[24:27]
  v_and_b32_dpp v32, v14, v6 row_newbcast:15 row_mask:0xf bank_mask:0xf
  v_and_b32_dpp v33, v14, v7 row_newbcast:15 row_mask:0xf bank_mask:0xf
  v_and_b32_dpp v34, v14, v8 row_newbcast:15 row_mask:0xf bank_mask:0xf
  v_and_b32_dpp v35, v14, v9 row_newbcast:15 row_mask:0xf bank_mask:0xf
  s_waitcnt vmcnt(6)
  buffer_load_dwordx4 v[196:199], v1, s[44:47], s14 offen offset:1024 nt
  v_mfma_f32_16x16x32_bf16 v[24:27], v[28:31], v[168:171], v[24:27]
  v_and_b32_dpp v28, v15, v6 row_newbcast:0 row_mask:0xf bank_mask:0xf
  v_and_b32_dpp v29, v15, v7 row_newbcast:0 row_mask:0xf bank_mask:0xf
  v_and_b32_dpp v30, v15, v8 row_newbcast:0 row_mask:0xf bank_mask:0xf
  v_and_b32_dpp v31, v15, v9 row_newbcast:0 row_mask:0xf bank_mask:0xf
  s_waitcnt vmcnt(6)
  buffer_load_dwordx4 v[200:203], v1, s[44:47], s14 offen offset:2048 nt
  v_mfma_f32_16x16x32_bf16 v[24:27], v[32:35], v[172:175], v[24:27]
  v_and_b32_dpp v32, v15, v6 row_newbcast:8 row_mask:0xf bank_mask:0xf
  v_and_b32_dpp v33, v15, v7 row_newbcast:8 row_mask:0xf bank_mask:0xf
  v_and_b32_dpp v34, v15, v8 row_newbcast:8 row_mask:0xf bank_mask:0xf
  v_and_b32_dpp v35, v15, v9 row_newbcast:8 row_mask:0xf bank_mask:0xf
  s_waitcnt vmcnt(6)
  buffer_load_dwordx4 v[204:207], v1, s[44:47], s14 offen offset:3072 nt
  v_mfma_f32_16x16x32_bf16 v[24:27], v[28:31], v[176:179], v[24:27]
  v_and_b32_dpp v28, v15, v6 row_newbcast:4 row_mask:0xf bank_mask:0xf
  v_and_b32_dpp v29, v15, v7 row_newbcast:4 row_mask:0xf bank_mask:0xf
  v_and_b32_dpp v30, v15, v8 row_newbcast:4 row_mask:0xf bank_mask:0xf
  v_and_b32_dpp v31, v15, v9 row_newbcast:4 row_mask:0xf bank_mask:0xf
  s_waitcnt vmcnt(6)
  s_add_u32 s14, s14, s15
  buffer_load_dwordx4 v[208:211], v1, s[44:47], s14 offen nt
  v_mfma_f32_16x16x32_bf16 v[24:27], v[32:35], v[180:183], v[24:27]
  v_and_b32_dpp v32, v15, v6 row_newbcast:12 row_mask:0xf bank_mask:0xf
  v_and_b32_dpp v33, v15, v7 row_newbcast:12 row_mask:0xf bank_mask:0xf
  v_and_b32_dpp v34, v15, v8 row_newbcast:12 row_mask:0xf bank_mask:0xf
  v_and_b32_dpp v35, v15, v9 row_newbcast:12 row_mask:0xf bank_mask:0xf
  s_waitcnt vmcnt(6)
  buffer_load_dwordx4 v[212:215], v1, s[44:47], s14 offen offset:1024 nt
  v_mfma_f32_16x16x32_bf16 v[24:27], v[28:31], v[184:187], v[24:27]
  v_and_b32_dpp v28, v15, v6 row_newbcast:1 row_mask:0xf bank_mask:0xf
  v_and_b32_dpp v29, v15, v7 row_newbcast:1 row_mask:0xf bank_mask:0xf
  v_and_b32_dpp v30, v15, v8 row_newbcast:1 row_mask:0xf bank_mask:0xf
  v_and_b32_dpp v31, v15, v9 row_newbcast:1 row_mask:0xf bank_mask:0xf
  s_waitcnt vmcnt(6)
  buffer_load_dwordx4 v[216:219], v1, s[44:47], s14 offen offset:2048 nt
  v_mfma_f32_16x16x32_bf16 v[24:27], v[32:35], v[188:191], v[24:27]
  v_and_b32_dpp v32, v15, v6 row_newbcast:9 row_mask:0xf bank_mask:0xf
  v_and_b32_dpp v33, v15, v7 row_newbcast:9 row_mask:0xf bank_mask:0xf
  v_and_b32_dpp v34, v15, v8 row_newbcast:9 row_mask:0xf bank_mask:0xf
  v_and_b32_dpp v35, v15, v9 row_newbcast:9 row_mask:0xf bank_mask:0xf
  s_waitcnt vmcnt(6)
  buffer_load_dwordx4 v[220:223], v1, s[44:47], s14 offen offset:3072 nt
  s_add_u32 s14, s14, s15
  buffer_load_dwordx4 v[224:227], v1, s[44:47], s14 offen nt
  buffer_load_dwordx4 v[228:231], v1, s[44:47], s14 offen offset:1024 nt
  v_mfma_f32_16x16x32_bf16 v[24:27], v[28:31], v[192:195], v[24:27]
  v_and_b32_dpp v28, v15, v6 row_newbcast:5 row_mask:0xf bank_mask:0xf
  v_and_b32_dpp v29, v15, v7 row_newbcast:5 row_mask:0xf bank_mask:0xf
  v_and_b32_dpp v30, v15, v8 row_newbcast:5 row_mask:0xf bank_mask:0xf
  v_and_b32_dpp v31, v15, v9 row_newbcast:5 row_mask:0xf bank_mask:0xf
  s_waitcnt vmcnt(8)
  buffer_load_dwordx4 v[232:235], v1, s[44:47], s14 offen offset:2048 nt
  v_mfma_f32_16x16x32_bf16 v[24:27], v[32:35], v[196:199], v[24:27]
  v_and_b32_dpp v32, v15, v6 row_newbcast:13 row_mask:0xf bank_mask:0xf
  v_and_b32_dpp v33, v15, v7 row_newbcast:13 row_mask:0xf bank_mask:0xf
  v_and_b32_dpp v34, v15, v8 row_newbcast:13 row_mask:0xf bank_mask:0xf
  v_and_b32_dpp v35, v15, v9 row_newbcast:13 row_mask:0xf bank_mask:0xf
  s_waitcnt vmcnt(8)
  buffer_load_dwordx4 v[236:239], v1, s[44:47], s14 offen offset:3072 nt
  v_mfma_f32_16x16x32_bf16 v[24:27], v[28:31], v[200:203], v[24:27]
  v_and_b32_dpp v28, v15, v6 row_newbcast:2 row_mask:0xf bank_mask:0xf
  v_and_b32_dpp v29, v15, v7 row_newbcast:2 row_mask:0xf bank_mask:0xf
  v_and_b32_dpp v30, v15, v8 row_newbcast:2 row_mask:0xf bank_mask:0xf
  v_and_b32_dpp v31, v15, v9 row_newbcast:2 row_mask:0xf bank_mask:0xf
  s_waitcnt vmcnt(8)
  s_add_u32 s14, s14, s15
  buffer_load_dwordx4 v[240:243], v1, s[44:47], s14 offen nt
  v_mfma_f32_16x16x32_bf16 v[24:27], v[32:35], v[204:207], v[24:27]
  v_and_b32_dpp v32, v15, v6 row_newbcast:10 row_mask:0xf bank_mask:0xf
  v_and_b32_dpp v33, v15, v7 row_newbcast:10 row_mask:0xf bank_mask:0xf
  v_and_b32_dpp v34, v15, v8 row_newbcast:10 row_mask:0xf bank_mask:0xf
  v_and_b32_dpp v35, v15, v9 row_newbcast:10 row_mask:0xf bank_mask:0xf
  s_waitcnt vmcnt(8)
  buffer_load_dwordx4 v[244:247], v1, s[44:47], s14 offen offset:1024 nt
  v_mfma_f32_16x16x32_bf16 v[24:27], v[28:31], v[208:211], v[24:27]
  v_and_b32_dpp v28, v15, v6 row_newbcast:6 row_mask:0xf bank_mask:0xf
  v_and_b32_dpp v29, v15, v7 row_newbcast:6 row_mask:0xf bank_mask:0xf
  v_and_b32_dpp v30, v15, v8 row_newbcast:6 row_mask:0xf bank_mask:0xf
  v_and_b32_dpp v31, v15, v9 row_newbcast:6 row_mask:0xf bank_mask:0xf
  s_waitcnt vmcnt(8)
  buffer_load_dwordx4 v[248:251], v1, s[44:47], s14 offen offset:2048 nt
  v_mfma_f32_16x16x32_bf16 v[24:27], v[32:35], v[212:215], v[24:27]
  v_and_b32_dpp v32, v15, v6 row_newbcast:14 row_mask:0xf bank_mask:0xf
  v_and_b32_dpp v33, v15, v7 row_newbcast:14 row_mask:0xf bank_mask:0xf
  v_and_b32_dpp v34, v15, v8 row_newbcast:14 row_mask:0xf bank_mask:0xf
  v_and_b32_dpp v35, v15, v9 row_newbcast:14 row_mask:0xf bank_mask:0xf
  s_waitcnt vmcnt(8)
  buffer_load_dwordx4 v[252:255], v1, s[44:47], s14 offen offset:3072 nt
  v_mfma_f32_16x16x32_bf16 v[24:27], v[28:31], v[216:219], v[24:27]
  v_and_b32_dpp v28, v15, v6 row_newbcast:3 row_mask:0xf bank_mask:0xf
  v_and_b32_dpp v29, v15, v7 row_newbcast:3 row_mask:0xf bank_mask:0xf
  v_and_b32_dpp v30, v15, v8 row_newbcast:3 row_mask:0xf bank_mask:0xf
  v_and_b32_dpp v31, v15, v9 row_newbcast:3 row_mask:0xf bank_mask:0xf
  s_waitcnt vmcnt(8)
  s_add_u32 s14, s14, s15
  buffer_load_dwordx4 v[64:67], v1, s[44:47], s14 offen nt
  v_mfma_f32_16x16x32_bf16 v[24:27], v[32:35], v[220:223], v[24:27]
  v_and_b32_dpp v32, v15, v6 row_newbcast:11 row_mask:0xf bank_mask:0xf
  v_and_b32_dpp v33, v15, v7 row_newbcast:11 row_mask:0xf bank_mask:0xf
  v_and_b32_dpp v34, v15, v8 row_newbcast:11 row_mask:0xf bank_mask:0xf
  v_and_b32_dpp v35, v15, v9 row_newbcast:11 row_mask:0xf bank_mask:0xf
  s_waitcnt vmcnt(8)
  buffer_load_dwordx4 v[68:71], v1, s[44:47], s14 offen offset:1024 nt
  v_mfma_f32_16x16x32_bf16 v[24:27], v[28:31], v[224:227], v[24:27]
  v_and_b32_dpp v28, v15, v6 row_newbcast:7 row_mask:0xf bank_mask:0xf
  v_and_b32_dpp v29, v15, v7 row_newbcast:7 row_mask:0xf bank_mask:0xf
  v_and_b32_dpp v30, v15, v8 row_newbcast:7 row_mask:0xf bank_mask:0xf
  v_and_b32_dpp v31, v15, v9 row_newbcast:7 row_mask:0xf bank_mask:0xf
  s_waitcnt vmcnt(8)
  buffer_load_dwordx4 v[72:75], v1, s[44:47], s14 offen offset:2048 nt
  v_mfma_f32_16x16x32_bf16 v[24:27], v[32:35], v[228:231], v[24:27]
  v_and_b32_dpp v32, v15, v6 row_newbcast:15 row_mask:0xf bank_mask:0xf
  v_and_b32_dpp v33, v15, v7 row_newbcast:15 row_mask:0xf bank_mask:0xf
  v_and_b32_dpp v34, v15, v8 row_newbcast:15 row_mask:0xf bank_mask:0xf
  v_and_b32_dpp v35, v15, v9 row_newbcast:15 row_mask:0xf bank_mask:0xf
  s_waitcnt vmcnt(8)
  buffer_load_dwordx4 v[76:79], v1, s[44:47], s14 offen offset:3072 nt
  v_mfma_f32_16x16x32_bf16 v[24:27], v[28:31], v[232:235], v[24:27]
  v_and_b32_dpp v28, v16, v6 row_newbcast:0 row_mask:0xf bank_mask:0xf
  v_and_b32_dpp v29, v16, v7 row_newbcast:0 row_mask:0xf bank_mask:0xf
  v_and_b32_dpp v30, v16, v8 row_newbcast:0 row_mask:0xf bank_mask:0xf
  v_and_b32_dpp v31, v16, v9 row_newbcast:0 row_mask:0xf bank_mask:0xf
  s_waitcnt vmcnt(8)
  s_add_u32 s14, s14, s15
  buffer_load_dwordx4 v[80:83], v1, s[44:47], s14 offen nt
  v_mfma_f32_16x16x32_bf16 v[24:27], v[32:35], v[236:239], v[24:27]
  v_and_b32_dpp v32, v16, v6 row_newbcast:8 row_mask:0xf bank_mask:0xf
  v_and_b32_dpp v33, v16, v7 row_newbcast:8 row_mask:0xf bank_mask:0xf
  v_and_b32_dpp v34, v16, v8 row_newbcast:8 row_mask:0xf bank_mask:0xf
  v_and_b32_dpp v35, v16, v9 row_newbcast:8 row_mask:0xf bank_mask:0xf
  s_waitcnt vmcnt(8)
  buffer_load_dwordx4 v[84:87], v1, s[44:47], s14 offen offset:1024 nt
  v_mfma_f32_16x16x32_bf16 v[24:27], v[28:31], v[240:243], v[24:27]
  v_and_b32_dpp v28, v16, v6 row_newbcast:4 row_mask:0xf bank_mask:0xf
  v_and_b32_dpp v29, v16, v7 row_newbcast:4 row_mask:0xf bank_mask:0xf
  v_and_b32_dpp v30, v16, v8 row_newbcast:4 row_mask:0xf bank_mask:0xf
  v_and_b32_dpp v31, v16, v9 row_newbcast:4 row_mask:0xf bank_mask:0xf
  s_waitcnt vmcnt(8)
  buffer_load_dwordx4 v[88:91], v1, s[44:47], s14 offen offset:2048 nt
  v_mfma_f32_16x16x32_bf16 v[24:27], v[32:35], v[244:247], v[24:27]
  v_and_b32_dpp v32, v16, v6 row_newbcast:12 row_mask:0xf bank_mask:0xf
  v_and_b32_dpp v33, v16, v7 row_newbcast:12 row_mask:0xf bank_mask:0xf
  v_and_b32_dpp v34, v16, v8 row_newbcast:12 row_mask:0xf bank_mask:0xf
  v_and_b32_dpp v35, v16, v9 row_newbcast:12 row_mask:0xf bank_mask:0xf
  s_waitcnt vmcnt(8)
  buffer_load_dwordx4 v[92:95], v1, s[44:47], s14 offen offset:3072 nt
  v_mfma_f32_16x16x32_bf16 v[24:27], v[28:31], v[248:251], v[24:27]
  v_and_b32_dpp v28, v16, v6 row_newbcast:1 row_mask:0xf bank_mask:0xf
  v_and_b32_dpp v29, v16, v7 row_newbcast:1 row_mask:0xf bank_mask:0xf
  v_and_b32_dpp v30, v16, v8 row_newbcast:1 row_mask:0xf bank_mask:0xf
  v_and_b32_dpp v31, v16, v9 row_newbcast:1 row_mask:0xf bank_mask:0xf
  s_waitcnt vmcnt(8)
  s_add_u32 s14, s14, s15
  buffer_load_dwordx4 v[96:99], v1, s[44:47], s14 offen nt
  v_mfma_f32_16x16x32_bf16 v[24:27], v[32:35], v[252:255], v[24:27]
  v_and_b32_dpp v32, v16, v6 row_newbcast:9 row_mask:0xf bank_mask:0xf
  v_and_b32_dpp v33, v16, v7 row_newbcast:9 row_mask:0xf bank_mask:0xf
  v_and_b32_dpp v34, v16, v8 row_newbcast:9 row_mask:0xf bank_mask:0xf
  v_and_b32_dpp v35, v16, v9 row_newbcast:9 row_mask:0xf bank_mask:0xf
  s_waitcnt vmcnt(8)
  buffer_load_dwordx4 v[100:103], v1, s[44:47], s14 offen offset:1024 nt
  v_mfma_f32_16x16x32_bf16 v[24:27], v[28:31], v[64:67], v[24:27]
  v_and_b32_dpp v28, v16, v6 row_newbcast:5 row_mask:0xf bank_mask:0xf
  v_and_b32_dpp v29, v16, v7 row_newbcast:5 row_mask:0xf bank_mask:0xf
  v_and_b32_dpp v30, v16, v8 row_newbcast:5 row_mask:0xf bank_mask:0xf
  v_and_b32_dpp v31, v16, v9 row_newbcast:5 row_mask:0xf bank_mask:0xf
  s_waitcnt vmcnt(8)
  buffer_load_dwordx4 v[104:107], v1, s[44:47], s14 offen offset:2048 nt
  v_mfma_f32_16x16x32_bf16 v[24:27], v[32:35], v[68:71], v[24:27]
  v_and_b32_dpp v32, v16, v6 row_newbcast:13 row_mask:0xf bank_mask:0xf
  v_and_b32_dpp v33, v16, v7 row_newbcast:13 row_mask:0xf bank_mask:0xf
  v_and_b32_dpp v34, v16, v8 row_newbcast:13 row_mask:0xf bank_mask:0xf
  v_and_b32_dpp v35, v16, v9 row_newbcast:13 row_mask:0xf bank_mask:0xf
  s_waitcnt vmcnt(8)
  buffer_load_dwordx4 v[108:111], v1, s[44:47], s14 offen offset:3072 nt
  v_mfma_f32_16x16x32_bf16 v[24:27], v[28:31], v[72:75], v[24:27]
  v_and_b32_dpp v28, v16, v6 row_newbcast:2 row_mask:0xf bank_mask:0xf
  v_and_b32_dpp v29, v16, v7 row_newbcast:2 row_mask:0xf bank_mask:0xf
  v_and_b32_dpp v30, v16, v8 row_newbcast:2 row_mask:0xf bank_mask:0xf
  v_and_b32_dpp v31, v16, v9 row_newbcast:2 row_mask:0xf bank_mask:0xf
  s_waitcnt vmcnt(8)
  s_add_u32 s14, s14, s15
  buffer_load_dwordx4 v[112:115], v1, s[44:47], s14 offen nt
  v_mfma_f32_16x16x32_bf16 v[24:27], v[32:35], v[76:79], v[24:27]
  v_and_b32_dpp v32, v16, v6 row_newbcast:10 row_mask:0xf bank_mask:0xf
  v_and_b32_dpp v33, v16, v7 row_newbcast:10 row_mask:0xf bank_mask:0xf
  v_and_b32_dpp v34, v16, v8 row_newbcast:10 row_mask:0xf bank_mask:0xf
  v_and_b32_dpp v35, v16, v9 row_newbcast:10 row_mask:0xf bank_mask:0xf
  s_waitcnt vmcnt(8)
  buffer_load_dwordx4 v[116:119], v1, s[44:47], s14 offen offset:1024 nt
  v_mfma_f32_16x16x32_bf16 v[24:27], v[28:31], v[80:83], v[24:27]
  v_and_b32_dpp v28, v16, v6 row_newbcast:6 row_mask:0xf bank_mask:0xf
  v_and_b32_dpp v29, v16, v7 row_newbcast:6 row_mask:0xf bank_mask:0xf
  v_and_b32_dpp v30, v16, v8 row_newbcast:6 row_mask:0xf bank_mask:0xf
  v_and_b32_dpp v31, v16, v9 row_newbcast:6 row_mask:0xf bank_mask:0xf
  s_waitcnt vmcnt(8)
  buffer_load_dwordx4 v[120:123], v1, s[44:47], s14 offen offset:2048 nt
  v_mfma_f32_16x16x32_bf16 v[24:27], v[32:35], v[84:87], v[24:27]
  v_and_b32_dpp v32, v16, v6 row_newbcast:14 row_mask:0xf bank_mask:0xf
  v_and_b32_dpp v33, v16, v7 row_newbcast:14 row_mask:0xf bank_mask:0xf
  v_and_b32_dpp v34, v16, v8 row_newbcast:14 row_mask:0xf bank_mask:0xf
  v_and_b32_dpp v35, v16, v9 row_newbcast:14 row_mask:0xf bank_mask:0xf
  s_waitcnt vmcnt(8)
  buffer_load_dwordx4 v[124:127], v1, s[44:47], s14 offen offset:3072 nt
  v_mfma_f32_16x16x32_bf16 v[24:27], v[28:31], v[88:91], v[24:27]
  v_and_b32_dpp v28, v16, v6 row_newbcast:3 row_mask:0xf bank_mask:0xf
  v_and_b32_dpp v29, v16, v7 row_newbcast:3 row_mask:0xf bank_mask:0xf
  v_and_b32_dpp v30, v16, v8 row_newbcast:3 row_mask:0xf bank_mask:0xf
  v_and_b32_dpp v31, v16, v9 row_newbcast:3 row_mask:0xf bank_mask:0xf
  s_waitcnt vmcnt(8)
  s_add_u32 s14, s14, s15
  buffer_load_dwordx4 v[128:131], v1, s[44:47], s14 offen nt
  v_mfma_f32_16x16x32_bf16 v[24:27], v[32:35], v[92:95], v[24:27]
  v_and_b32_dpp v32, v16, v6 row_newbcast:11 row_mask:0xf bank_mask:0xf
  v_and_b32_dpp v33, v16, v7 row_newbcast:11 row_mask:0xf bank_mask:0xf
  v_and_b32_dpp v34, v16, v8 row_newbcast:11 row_mask:0xf bank_mask:0xf
  v_and_b32_dpp v35, v16, v9 row_newbcast:11 row_mask:0xf bank_mask:0xf
  s_waitcnt vmcnt(8)
  buffer_load_dwordx4 v[132:135], v1, s[44:47], s14 offen offset:1024 nt
  v_mfma_f32_16x16x32_bf16 v[24:27], v[28:31], v[96:99], v[24:27]
  v_and_b32_dpp v28, v16, v6 row_newbcast:7 row_mask:0xf bank_mask:0xf
  v_and_b32_dpp v29, v16, v7 row_newbcast:7 row_mask:0xf bank_mask:0xf
  v_and_b32_dpp v30, v16, v8 row_newbcast:7 row_mask:0xf bank_mask:0xf
  v_and_b32_dpp v31, v16, v9 row_newbcast:7 row_mask:0xf bank_mask:0xf
  s_waitcnt vmcnt(8)
  buffer_load_dwordx4 v[136:139], v1, s[44:47], s14 offen offset:2048 nt
  v_mfma_f32_16x16x32_bf16 v[24:27], v[32:35], v[100:103], v[24:27]
  v_and_b32_dpp v32, v16, v6 row_newbcast:15 row_mask:0xf bank_mask:0xf
  v_and_b32_dpp v33, v16, v7 row_newbcast:15 row_mask:0xf bank_mask:0xf
  v_and_b32_dpp v34, v16, v8 row_newbcast:15 row_mask:0xf bank_mask:0xf
  v_and_b32_dpp v35, v16, v9 row_newbcast:15 row_mask:0xf bank_mask:0xf
  s_waitcnt vmcnt(8)
  buffer_load_dwordx4 v[140:143], v1, s[44:47], s14 offen offset:3072 nt
  v_mfma_f32_16x16x32_bf16 v[24:27], v[28:31], v[104:107], v[24:27]
  v_and_b32_dpp v28, v17, v6 row_newbcast:0 row_mask:0xf bank_mask:0xf
  v_and_b32_dpp v29, v17, v7 row_newbcast:0 row_mask:0xf bank_mask:0xf
  v_and_b32_dpp v30, v17, v8 row_newbcast:0 row_mask:0xf bank_mask:0xf
  v_and_b32_dpp v31, v17, v9 row_newbcast:0 row_mask:0xf bank_mask:0xf
  s_waitcnt vmcnt(8)
  s_add_u32 s14, s14, s15
  buffer_load_dwordx4 v[144:147], v1, s[44:47], s14 offen nt
  v_mfma_f32_16x16x32_bf16 v[24:27], v[32:35], v[108:111], v[24:27]
  v_and_b32_dpp v32, v17, v6 row_newbcast:8 row_mask:0xf bank_mask:0xf
  v_and_b32_dpp v33, v17, v7 row_newbcast:8 row_mask:0xf bank_mask:0xf
  v_and_b32_dpp v34, v17, v8 row_newbcast:8 row_mask:0xf bank_mask:0xf
  v_and_b32_dpp v35, v17, v9 row_newbcast:8 row_mask:0xf bank_mask:0xf
  s_waitcnt vmcnt(8)
  buffer_load_dwordx4 v[148:151], v1, s[44:47], s14 offen offset:1024 nt
  v_mfma_f32_16x16x32_bf16 v[24:27], v[28:31], v[112:115], v[24:27]
  v_and_b32_dpp v28, v17, v6 row_newbcast:4 row_mask:0xf bank_mask:0xf
  v_and_b32_dpp v29, v17, v7 row_newbcast:4 row_mask:0xf bank_mask:0xf
  v_and_b32_dpp v30, v17, v8 row_newbcast:4 row_mask:0xf bank_mask:0xf
  v_and_b32_dpp v31, v17, v9 row_newbcast:4 row_mask:0xf bank_mask:0xf
  s_waitcnt vmcnt(8)
  buffer_load_dwordx4 v[152:155], v1, s[44:47], s14 offen offset:2048 nt
  v_mfma_f32_16x16x32_bf16 v[24:27], v[32:35], v[116:119], v[24:27]
  v_and_b32_dpp v32, v17, v6 row_newbcast:12 row_mask:0xf bank_mask:0xf
  v_and_b32_dpp v33, v17, v7 row_newbcast:12 row_mask:0xf bank_mask:0xf
  v_and_b32_dpp v34, v17, v8 row_newbcast:12 row_mask:0xf bank_mask:0xf
  v_and_b32_dpp v35, v17, v9 row_newbcast:12 row_mask:0xf bank_mask:0xf
  s_waitcnt vmcnt(8)
  buffer_load_dwordx4 v[156:159], v1, s[44:47], s14 offen offset:3072 nt
  v_mfma_f32_16x16x32_bf16 v[24:27], v[28:31], v[120:123], v[24:27]
  v_and_b32_dpp v28, v17, v6 row_newbcast:1 row_mask:0xf bank_mask:0xf
  v_and_b32_dpp v29, v17, v7 row_newbcast:1 row_mask:0xf bank_mask:0xf
  v_and_b32_dpp v30, v17, v8 row_newbcast:1 row_mask:0xf bank_mask:0xf
  v_and_b32_dpp v31, v17, v9 row_newbcast:1 row_mask:0xf bank_mask:0xf
  s_waitcnt vmcnt(8)
  s_add_u32 s14, s14, s15
  buffer_load_dwordx4 v[160:163], v1, s[44:47], s14 offen nt
  v_mfma_f32_16x16x32_bf16 v[24:27], v[32:35], v[124:127], v[24:27]
  v_and_b32_dpp v32, v17, v6 row_newbcast:9 row_mask:0xf bank_mask:0xf
  v_and_b32_dpp v33, v17, v7 row_newbcast:9 row_mask:0xf bank_mask:0xf
  v_and_b32_dpp v34, v17, v8 row_newbcast:9 row_mask:0xf bank_mask:0xf
  v_and_b32_dpp v35, v17, v9 row_newbcast:9 row_mask:0xf bank_mask:0xf
  s_waitcnt vmcnt(8)
  buffer_load_dwordx4 v[164:167], v1, s[44:47], s14 offen offset:1024 nt
  v_mfma_f32_16x16x32_bf16 v[24:27], v[28:31], v[128:131], v[24:27]
  v_and_b32_dpp v28, v17, v6 row_newbcast:5 row_mask:0xf bank_mask:0xf
  v_and_b32_dpp v29, v17, v7 row_newbcast:5 row_mask:0xf bank_mask:0xf
  v_and_b32_dpp v30, v17, v8 row_newbcast:5 row_mask:0xf bank_mask:0xf
  v_and_b32_dpp v31, v17, v9 row_newbcast:5 row_mask:0xf bank_mask:0xf
  s_waitcnt vmcnt(8)
  buffer_load_dwordx4 v[168:171], v1, s[44:47], s14 offen offset:2048 nt
  v_mfma_f32_16x16x32_bf16 v[24:27], v[32:35], v[132:135], v[24:27]
  v_and_b32_dpp v32, v17, v6 row_newbcast:13 row_mask:0xf bank_mask:0xf
  v_and_b32_dpp v33, v17, v7 row_newbcast:13 row_mask:0xf bank_mask:0xf
  v_and_b32_dpp v34, v17, v8 row_newbcast:13 row_mask:0xf bank_mask:0xf
  v_and_b32_dpp v35, v17, v9 row_newbcast:13 row_mask:0xf bank_mask:0xf
  s_waitcnt vmcnt(8)
  buffer_load_dwordx4 v[172:175], v1, s[44:47], s14 offen offset:3072 nt
  v_mfma_f32_16x16x32_bf16 v[24:27], v[28:31], v[136:139], v[24:27]
  v_and_b32_dpp v28, v17, v6 row_newbcast:2 row_mask:0xf bank_mask:0xf
  v_and_b32_dpp v29, v17, v7 row_newbcast:2 row_mask:0xf bank_mask:0xf
  v_and_b32_dpp v30, v17, v8 row_newbcast:2 row_mask:0xf bank_mask:0xf
  v_and_b32_dpp v31, v17, v9 row_newbcast:2 row_mask:0xf bank_mask:0xf
  s_waitcnt vmcnt(8)
  s_add_u32 s14, s14, s15
  buffer_load_dwordx4 v[176:179], v1, s[44:47], s14 offen nt
  v_mfma_f32_16x16x32_bf16 v[24:27], v[32:35], v[140:143], v[24:27]
  v_and_b32_dpp v32, v17, v6 row_newbcast:10 row_mask:0xf bank_mask:0xf
  v_and_b32_dpp v33, v17, v7 row_newbcast:10 row_mask:0xf bank_mask:0xf
  v_and_b32_dpp v34, v17, v8 row_newbcast:10 row_mask:0xf bank_mask:0xf
  v_and_b32_dpp v35, v17, v9 row_newbcast:10 row_mask:0xf bank_mask:0xf
  s_waitcnt vmcnt(8)
  buffer_load_dwordx4 v[180:183], v1, s[44:47], s14 offen offset:1024 nt
  v_mfma_f32_16x16x32_bf16 v[24:27], v[28:31], v[144:147], v[24:27]
  v_and_b32_dpp v28, v17, v6 row_newbcast:6 row_mask:0xf bank_mask:0xf
  v_and_b32_dpp v29, v17, v7 row_newbcast:6 row_mask:0xf bank_mask:0xf
  v_and_b32_dpp v30, v17, v8 row_newbcast:6 row_mask:0xf bank_mask:0xf
  v_and_b32_dpp v31, v17, v9 row_newbcast:6 row_mask:0xf bank_mask:0xf
  s_waitcnt vmcnt(8)
  buffer_load_dwordx4 v[184:187], v1, s[44:47], s14 offen offset:2048 nt
  v_mfma_f32_16x16x32_bf16 v[24:27], v[32:35], v[148:151], v[24:27]
  v_and_b32_dpp v32, v17, v6 row_newbcast:14 row_mask:0xf bank_mask:0xf
  v_and_b32_dpp v33, v17, v7 row_newbcast:14 row_mask:0xf bank_mask:0xf
  v_and_b32_dpp v34, v17, v8 row_newbcast:14 row_mask:0xf bank_mask:0xf
  v_and_b32_dpp v35, v17, v9 row_newbcast:14 row_mask:0xf bank_mask:0xf
  s_waitcnt vmcnt(8)
  buffer_load_dwordx4 v[188:191], v1, s[44:47], s14 offen offset:3072 nt
  v_mfma_f32_16x16x32_bf16 v[24:27], v[28:31], v[152:155], v[24:27]
  v_and_b32_dpp v28, v17, v6 row_newbcast:3 row_mask:0xf bank_mask:0xf
  v_and_b32_dpp v29, v17, v7 row_newbcast:3 row_mask:0xf bank_mask:0xf
  v_and_b32_dpp v30, v17, v8 row_newbcast:3 row_mask:0xf bank_mask:0xf
  v_and_b32_dpp v31, v17, v9 row_newbcast:3 row_mask:0xf bank_mask:0xf
  s_waitcnt vmcnt(8)
  s_add_u32 s14, s14, s15
  buffer_load_dwordx4 v[192:195], v1, s[44:47], s14 offen nt
  v_mfma_f32_16x16x32_bf16 v[24:27], v[32:35], v[156:159], v[24:27]
  v_and_b32_dpp v32, v17, v6 row_newbcast:11 row_mask:0xf bank_mask:0xf
  v_and_b32_dpp v33, v17, v7 row_newbcast:11 row_mask:0xf bank_mask:0xf
  v_and_b32_dpp v34, v17, v8 row_newbcast:11 row_mask:0xf bank_mask:0xf
  v_and_b32_dpp v35, v17, v9 row_newbcast:11 row_mask:0xf bank_mask:0xf
  s_waitcnt vmcnt(8)
  buffer_load_dwordx4 v[196:199], v1, s[44:47], s14 offen offset:1024 nt
  v_mfma_f32_16x16x32_bf16 v[24:27], v[28:31], v[160:163], v[24:27]
  v_and_b32_dpp v28, v17, v6 row_newbcast:7 row_mask:0xf bank_mask:0xf
  v_and_b32_dpp v29, v17, v7 row_newbcast:7 row_mask:0xf bank_mask:0xf
  v_and_b32_dpp v30, v17, v8 row_newbcast:7 row_mask:0xf bank_mask:0xf
  v_and_b32_dpp v31, v17, v9 row_newbcast:7 row_mask:0xf bank_mask:0xf
  s_waitcnt vmcnt(8)
  buffer_load_dwordx4 v[200:203], v1, s[44:47], s14 offen offset:2048 nt
  v_mfma_f32_16x16x32_bf16 v[24:27], v[32:35], v[164:167], v[24:27]
  v_and_b32_dpp v32, v17, v6 row_newbcast:15 row_mask:0xf bank_mask:0xf
  v_and_b32_dpp v33, v17, v7 row_newbcast:15 row_mask:0xf bank_mask:0xf
  v_and_b32_dpp v34, v17, v8 row_newbcast:15 row_mask:0xf bank_mask:0xf
  v_and_b32_dpp v35, v17, v9 row_newbcast:15 row_mask:0xf bank_mask:0xf
  s_waitcnt vmcnt(8)
  buffer_load_dwordx4 v[204:207], v1, s[44:47], s14 offen offset:3072 nt
  v_mfma_f32_16x16x32_bf16 v[24:27], v[28:31], v[168:171], v[24:27]
  v_and_b32_dpp v28, v18, v6 row_newbcast:0 row_mask:0xf bank_mask:0xf
  v_and_b32_dpp v29, v18, v7 row_newbcast:0 row_mask:0xf bank_mask:0xf
  v_and_b32_dpp v30, v18, v8 row_newbcast:0 row_mask:0xf bank_mask:0xf
  v_and_b32_dpp v31, v18, v9 row_newbcast:0 row_mask:0xf bank_mask:0xf
  s_waitcnt vmcnt(8)
  s_add_u32 s14, s14, s15
  buffer_load_dwordx4 v[208:211], v1, s[44:47], s14 offen nt
  v_mfma_f32_16x16x32_bf16 v[24:27], v[32:35], v[172:175], v[24:27]
  v_and_b32_dpp v32, v18, v6 row_newbcast:8 row_mask:0xf bank_mask:0xf
  v_and_b32_dpp v33, v18, v7 row_newbcast:8 row_mask:0xf bank_mask:0xf
  v_and_b32_dpp v34, v18, v8 row_newbcast:8 row_mask:0xf bank_mask:0xf
  v_and_b32_dpp v35, v18, v9 row_newbcast:8 row_mask:0xf bank_mask:0xf
  s_waitcnt vmcnt(8)
  buffer_load_dwordx4 v[212:215], v1, s[44:47], s14 offen offset:1024 nt
  v_mfma_f32_16x16x32_bf16 v[24:27], v[28:31], v[176:179], v[24:27]
  v_and_b32_dpp v28, v18, v6 row_newbcast:4 row_mask:0xf bank_mask:0xf
  v_and_b32_dpp v29, v18, v7 row_newbcast:4 row_mask:0xf bank_mask:0xf
  v_and_b32_dpp v30, v18, v8 row_newbcast:4 row_mask:0xf bank_mask:0xf
  v_and_b32_dpp v31, v18, v9 row_newbcast:4 row_mask:0xf bank_mask:0xf
  s_waitcnt vmcnt(8)
  buffer_load_dwordx4 v[216:219], v1, s[44:47], s14 offen offset:2048 nt
  v_mfma_f32_16x16x32_bf16 v[24:27], v[32:35], v[180:183], v[24:27]
  v_and_b32_dpp v32, v18, v6 row_newbcast:12 row_mask:0xf bank_mask:0xf
  v_and_b32_dpp v33, v18, v7 row_newbcast:12 row_mask:0xf bank_mask:0xf
  v_and_b32_dpp v34, v18, v8 row_newbcast:12 row_mask:0xf bank_mask:0xf
  v_and_b32_dpp v35, v18, v9 row_newbcast:12 row_mask:0xf bank_mask:0xf
  s_waitcnt vmcnt(8)
  buffer_load_dwordx4 v[220:223], v1, s[44:47], s14 offen offset:3072 nt
  v_mfma_f32_16x16x32_bf16 v[24:27], v[28:31], v[184:187], v[24:27]
  v_and_b32_dpp v28, v18, v6 row_newbcast:1 row_mask:0xf bank_mask:0xf
  v_and_b32_dpp v29, v18, v7 row_newbcast:1 row_mask:0xf bank_mask:0xf
  v_and_b32_dpp v30, v18, v8 row_newbcast:1 row_mask:0xf bank_mask:0xf
  v_and_b32_dpp v31, v18, v9 row_newbcast:1 row_mask:0xf bank_mask:0xf
  s_waitcnt vmcnt(8)
  s_add_u32 s14, s14, s15
  buffer_load_dwordx4 v[224:227], v1, s[44:47], s14 offen nt
  v_mfma_f32_16x16x32_bf16 v[24:27], v[32:35], v[188:191], v[24:27]
  v_and_b32_dpp v32, v18, v6 row_newbcast:9 row_mask:0xf bank_mask:0xf
  v_and_b32_dpp v33, v18, v7 row_newbcast:9 row_mask:0xf bank_mask:0xf
  v_and_b32_dpp v34, v18, v8 row_newbcast:9 row_mask:0xf bank_mask:0xf
  v_and_b32_dpp v35, v18, v9 row_newbcast:9 row_mask:0xf bank_mask:0xf
  s_waitcnt vmcnt(8)
  buffer_load_dwordx4 v[228:231], v1, s[44:47], s14 offen offset:1024 nt
  v_mfma_f32_16x16x32_bf16 v[24:27], v[28:31], v[192:195], v[24:27]
  v_and_b32_dpp v28, v18, v6 row_newbcast:5 row_mask:0xf bank_mask:0xf
  v_and_b32_dpp v29, v18, v7 row_newbcast:5 row_mask:0xf bank_mask:0xf
  v_and_b32_dpp v30, v18, v8 row_newbcast:5 row_mask:0xf bank_mask:0xf
  v_and_b32_dpp v31, v18, v9 row_newbcast:5 row_mask:0xf bank_mask:0xf
  s_waitcnt vmcnt(8)
  buffer_load_dwordx4 v[232:235], v1, s[44:47], s14 offen offset:2048 nt
  v_mfma_f32_16x16x32_bf16 v[24:27], v[32:35], v[196:199], v[24:27]
  v_and_b32_dpp v32, v18, v6 row_newbcast:13 row_mask:0xf bank_mask:0xf
  v_and_b32_dpp v33, v18, v7 row_newbcast:13 row_mask:0xf bank_mask:0xf
  v_and_b32_dpp v34, v18, v8 row_newbcast:13 row_mask:0xf bank_mask:0xf
  v_and_b32_dpp v35, v18, v9 row_newbcast:13 row_mask:0xf bank_mask:0xf
  s_waitcnt vmcnt(8)
  buffer_load_dwordx4 v[236:239], v1, s[44:47], s14 offen offset:3072 nt
  v_mfma_f32_16x16x32_bf16 v[24:27], v[28:31], v[200:203], v[24:27]
  v_and_b32_dpp v28, v18, v6 row_newbcast:2 row_mask:0xf bank_mask:0xf
  v_and_b32_dpp v29, v18, v7 row_newbcast:2 row_mask:0xf bank_mask:0xf
  v_and_b32_dpp v30, v18, v8 row_newbcast:2 row_mask:0xf bank_mask:0xf
  v_and_b32_dpp v31, v18, v9 row_newbcast:2 row_mask:0xf bank_mask:0xf
  s_waitcnt vmcnt(8)
  s_add_u32 s14, s14, s15
  buffer_load_dwordx4 v[240:243], v1, s[44:47], s14 offen nt
  v_mfma_f32_16x16x32_bf16 v[24:27], v[32:35], v[204:207], v[24:27]
  v_and_b32_dpp v32, v18, v6 row_newbcast:10 row_mask:0xf bank_mask:0xf
  v_and_b32_dpp v33, v18, v7 row_newbcast:10 row_mask:0xf bank_mask:0xf
  v_and_b32_dpp v34, v18, v8 row_newbcast:10 row_mask:0xf bank_mask:0xf
  v_and_b32_dpp v35, v18, v9 row_newbcast:10 row_mask:0xf bank_mask:0xf
  s_waitcnt vmcnt(8)
  buffer_load_dwordx4 v[244:247], v1, s[44:47], s14 offen offset:1024 nt
  v_mfma_f32_16x16x32_bf16 v[24:27], v[28:31], v[208:211], v[24:27]
  v_and_b32_dpp v28, v18, v6 row_newbcast:6 row_mask:0xf bank_mask:0xf
  v_and_b32_dpp v29, v18, v7 row_newbcast:6 row_mask:0xf bank_mask:0xf
  v_and_b32_dpp v30, v18, v8 row_newbcast:6 row_mask:0xf bank_mask:0xf
  v_and_b32_dpp v31, v18, v9 row_newbcast:6 row_mask:0xf bank_mask:0xf
  s_waitcnt vmcnt(8)
  buffer_load_dwordx4 v[248:251], v1, s[44:47], s14 offen offset:2048 nt
  v_mfma_f32_16x16x32_bf16 v[24:27], v[32:35], v[212:215], v[24:27]
  v_and_b32_dpp v32, v18, v6 row_newbcast:14 row_mask:0xf bank_mask:0xf
  v_and_b32_dpp v33, v18, v7 row_newbcast:14 row_mask:0xf bank_mask:0xf
  v_and_b32_dpp v34, v18, v8 row_newbcast:14 row_mask:0xf bank_mask:0xf
  v_and_b32_dpp v35, v18, v9 row_newbcast:14 row_mask:0xf bank_mask:0xf
  s_waitcnt vmcnt(8)
  buffer_load_dwordx4 v[252:255], v1, s[44:47], s14 offen offset:3072 nt
  v_mfma_f32_16x16x32_bf16 v[24:27], v[28:31], v[216:219], v[24:27]
  v_and_b32_dpp v28, v18, v6 row_newbcast:3 row_mask:0xf bank_mask:0xf
  v_and_b32_dpp v29, v18, v7 row_newbcast:3 row_mask:0xf bank_mask:0xf
  v_and_b32_dpp v30, v18, v8 row_newbcast:3 row_mask:0xf bank_mask:0xf
  v_and_b32_dpp v31, v18, v9 row_newbcast:3 row_mask:0xf bank_mask:0xf
  s_waitcnt vmcnt(8)
  s_add_u32 s14, s14, s15
  buffer_load_dwordx4 v[64:67], v1, s[44:47], s14 offen nt
  v_mfma_f32_16x16x32_bf16 v[24:27], v[32:35], v[220:223], v[24:27]
  v_and_b32_dpp v32, v18, v6 row_newbcast:11 row_mask:0xf bank_mask:0xf
  v_and_b32_dpp v33, v18, v7 row_newbcast:11 row_mask:0xf bank_mask:0xf
  v_and_b32_dpp v34, v18, v8 row_newbcast:11 row_mask:0xf bank_mask:0xf
  v_and_b32_dpp v35, v18, v9 row_newbcast:11 row_mask:0xf bank_mask:0xf
  s_waitcnt vmcnt(8)
  buffer_load_dwordx4 v[68:71], v1, s[44:47], s14 offen offset:1024 nt
  v_mfma_f32_16x16x32_bf16 v[24:27], v[28:31], v[224:227], v[24:27]
  v_and_b32_dpp v28, v18, v6 row_newbcast:7 row_mask:0xf bank_mask:0xf
  v_and_b32_dpp v29, v18, v7 row_newbcast:7 row_mask:0xf bank_mask:0xf
  v_and_b32_dpp v30, v18, v8 row_newbcast:7 row_mask:0xf bank_mask:0xf
  v_and_b32_dpp v31, v18, v9 row_newbcast:7 row_mask:0xf bank_mask:0xf
  s_waitcnt vmcnt(8)
  buffer_load_dwordx4 v[72:75], v1, s[44:47], s14 offen offset:2048 nt
  v_mfma_f32_16x16x32_bf16 v[24:27], v[32:35], v[228:231], v[24:27]
  v_and_b32_dpp v32, v18, v6 row_newbcast:15 row_mask:0xf bank_mask:0xf
  v_and_b32_dpp v33, v18, v7 row_newbcast:15 row_mask:0xf bank_mask:0xf
  v_and_b32_dpp v34, v18, v8 row_newbcast:15 row_mask:0xf bank_mask:0xf
  v_and_b32_dpp v35, v18, v9 row_newbcast:15 row_mask:0xf bank_mask:0xf
  s_waitcnt vmcnt(8)
  buffer_load_dwordx4 v[76:79], v1, s[44:47], s14 offen offset:3072 nt
  v_mfma_f32_16x16x32_bf16 v[24:27], v[28:31], v[232:235], v[24:27]
  v_and_b32_dpp v28, v19, v6 row_newbcast:0 row_mask:0xf bank_mask:0xf
  v_and_b32_dpp v29, v19, v7 row_newbcast:0 row_mask:0xf bank_mask:0xf
  v_and_b32_dpp v30, v19, v8 row_newbcast:0 row_mask:0xf bank_mask:0xf
  v_and_b32_dpp v31, v19, v9 row_newbcast:0 row_mask:0xf bank_mask:0xf
  s_waitcnt vmcnt(8)
  s_add_u32 s14, s14, s15
  buffer_load_dwordx4 v[80:83], v1, s[44:47], s14 offen nt
  v_mfma_f32_16x16x32_bf16 v[24:27], v[32:35], v[236:239], v[24:27]
  v_and_b32_dpp v32, v19, v6 row_newbcast:8 row_mask:0xf bank_mask:0xf
  v_and_b32_dpp v33, v19, v7 row_newbcast:8 row_mask:0xf bank_mask:0xf
  v_and_b32_dpp v34, v19, v8 row_newbcast:8 row_mask:0xf bank_mask:0xf
  v_and_b32_dpp v35, v19, v9 row_newbcast:8 row_mask:0xf bank_mask:0xf
  s_waitcnt vmcnt(8)
  buffer_load_dwordx4 v[84:87], v1, s[44:47], s14 offen offset:1024 nt
  v_mfma_f32_16x16x32_bf16 v[24:27], v[28:31], v[240:243], v[24:27]
  v_and_b32_dpp v28, v19, v6 row_newbcast:4 row_mask:0xf bank_mask:0xf
  v_and_b32_dpp v29, v19, v7 row_newbcast:4 row_mask:0xf bank_mask:0xf
  v_and_b32_dpp v30, v19, v8 row_newbcast:4 row_mask:0xf bank_mask:0xf
  v_and_b32_dpp v31, v19, v9 row_newbcast:4 row_mask:0xf bank_mask:0xf
  s_waitcnt vmcnt(8)
  buffer_load_dwordx4 v[88:91], v1, s[44:47], s14 offen offset:2048 nt
  v_mfma_f32_16x16x32_bf16 v[24:27], v[32:35], v[244:247], v[24:27]
  v_and_b32_dpp v32, v19, v6 row_newbcast:12 row_mask:0xf bank_mask:0xf
  v_and_b32_dpp v33, v19, v7 row_newbcast:12 row_mask:0xf bank_mask:0xf
  v_and_b32_dpp v34, v19, v8 row_newbcast:12 row_mask:0xf bank_mask:0xf
  v_and_b32_dpp v35, v19, v9 row_newbcast:12 row_mask:0xf bank_mask:0xf
  s_waitcnt vmcnt(8)
  buffer_load_dwordx4 v[92:95], v1, s[44:47], s14 offen offset:3072 nt
  v_mfma_f32_16x16x32_bf16 v[24:27], v[28:31], v[248:251], v[24:27]
  v_and_b32_dpp v28, v19, v6 row_newbcast:1 row_mask:0xf bank_mask:0xf
  v_and_b32_dpp v29, v19, v7 row_newbcast:1 row_mask:0xf bank_mask:0xf
  v_and_b32_dpp v30, v19, v8 row_newbcast:1 row_mask:0xf bank_mask:0xf
  v_and_b32_dpp v31, v19, v9 row_newbcast:1 row_mask:0xf bank_mask:0xf
  s_waitcnt vmcnt(8)
  s_add_u32 s14, s14, s15
  buffer_load_dwordx4 v[96:99], v1, s[44:47], s14 offen nt
  v_mfma_f32_16x16x32_bf16 v[24:27], v[32:35], v[252:255], v[24:27]
  v_and_b32_dpp v32, v19, v6 row_newbcast:9 row_mask:0xf bank_mask:0xf
  v_and_b32_dpp v33, v19, v7 row_newbcast:9 row_mask:0xf bank_mask:0xf
  v_and_b32_dpp v34, v19, v8 row_newbcast:9 row_mask:0xf bank_mask:0xf
  v_and_b32_dpp v35, v19, v9 row_newbcast:9 row_mask:0xf bank_mask:0xf
  s_waitcnt vmcnt(8)
  buffer_load_dwordx4 v[100:103], v1, s[44:47], s14 offen offset:1024 nt
  v_mfma_f32_16x16x32_bf16 v[24:27], v[28:31], v[64:67], v[24:27]
  v_and_b32_dpp v28, v19, v6 row_newbcast:5 row_mask:0xf bank_mask:0xf
  v_and_b32_dpp v29, v19, v7 row_newbcast:5 row_mask:0xf bank_mask:0xf
  v_and_b32_dpp v30, v19, v8 row_newbcast:5 row_mask:0xf bank_mask:0xf
  v_and_b32_dpp v31, v19, v9 row_newbcast:5 row_mask:0xf bank_mask:0xf
  s_waitcnt vmcnt(8)
  buffer_load_dwordx4 v[104:107], v1, s[44:47], s14 offen offset:2048 nt
  v_mfma_f32_16x16x32_bf16 v[24:27], v[32:35], v[68:71], v[24:27]
  v_and_b32_dpp v32, v19, v6 row_newbcast:13 row_mask:0xf bank_mask:0xf
  v_and_b32_dpp v33, v19, v7 row_newbcast:13 row_mask:0xf bank_mask:0xf
  v_and_b32_dpp v34, v19, v8 row_newbcast:13 row_mask:0xf bank_mask:0xf
  v_and_b32_dpp v35, v19, v9 row_newbcast:13 row_mask:0xf bank_mask:0xf
  s_waitcnt vmcnt(8)
  buffer_load_dwordx4 v[108:111], v1, s[44:47], s14 offen offset:3072 nt
  v_mfma_f32_16x16x32_bf16 v[24:27], v[28:31], v[72:75], v[24:27]
  v_and_b32_dpp v28, v19, v6 row_newbcast:2 row_mask:0xf bank_mask:0xf
  v_and_b32_dpp v29, v19, v7 row_newbcast:2 row_mask:0xf bank_mask:0xf
  v_and_b32_dpp v30, v19, v8 row_newbcast:2 row_mask:0xf bank_mask:0xf
  v_and_b32_dpp v31, v19, v9 row_newbcast:2 row_mask:0xf bank_mask:0xf
  s_waitcnt vmcnt(8)
  s_add_u32 s14, s14, s15
  buffer_load_dwordx4 v[112:115], v1, s[44:47], s14 offen nt
  v_mfma_f32_16x16x32_bf16 v[24:27], v[32:35], v[76:79], v[24:27]
  v_and_b32_dpp v32, v19, v6 row_newbcast:10 row_mask:0xf bank_mask:0xf
  v_and_b32_dpp v33, v19, v7 row_newbcast:10 row_mask:0xf bank_mask:0xf
  v_and_b32_dpp v34, v19, v8 row_newbcast:10 row_mask:0xf bank_mask:0xf
  v_and_b32_dpp v35, v19, v9 row_newbcast:10 row_mask:0xf bank_mask:0xf
  s_waitcnt vmcnt(8)
  buffer_load_dwordx4 v[116:119], v1, s[44:47], s14 offen offset:1024 nt
  v_mfma_f32_16x16x32_bf16 v[24:27], v[28:31], v[80:83], v[24:27]
  v_and_b32_dpp v28, v19, v6 row_newbcast:6 row_mask:0xf bank_mask:0xf
  v_and_b32_dpp v29, v19, v7 row_newbcast:6 row_mask:0xf bank_mask:0xf
  v_and_b32_dpp v30, v19, v8 row_newbcast:6 row_mask:0xf bank_mask:0xf
  v_and_b32_dpp v31, v19, v9 row_newbcast:6 row_mask:0xf bank_mask:0xf
  s_waitcnt vmcnt(8)
  buffer_load_dwordx4 v[120:123], v1, s[44:47], s14 offen offset:2048 nt
  v_mfma_f32_16x16x32_bf16 v[24:27], v[32:35], v[84:87], v[24:27]
  v_and_b32_dpp v32, v19, v6 row_newbcast:14 row_mask:0xf bank_mask:0xf
  v_and_b32_dpp v33, v19, v7 row_newbcast:14 row_mask:0xf bank_mask:0xf
  v_and_b32_dpp v34, v19, v8 row_newbcast:14 row_mask:0xf bank_mask:0xf
  v_and_b32_dpp v35, v19, v9 row_newbcast:14 row_mask:0xf bank_mask:0xf
  s_waitcnt vmcnt(8)
  buffer_load_dwordx4 v[124:127], v1, s[44:47], s14 offen offset:3072 nt
  v_mfma_f32_16x16x32_bf16 v[24:27], v[28:31], v[88:91], v[24:27]
  v_and_b32_dpp v28, v19, v6 row_newbcast:3 row_mask:0xf bank_mask:0xf
  v_and_b32_dpp v29, v19, v7 row_newbcast:3 row_mask:0xf bank_mask:0xf
  v_and_b32_dpp v30, v19, v8 row_newbcast:3 row_mask:0xf bank_mask:0xf
  v_and_b32_dpp v31, v19, v9 row_newbcast:3 row_mask:0xf bank_mask:0xf
  s_waitcnt vmcnt(8)
  s_add_u32 s14, s14, s15
  buffer_load_dwordx4 v[128:131], v1, s[44:47], s14 offen nt
  v_mfma_f32_16x16x32_bf16 v[24:27], v[32:35], v[92:95], v[24:27]
  v_and_b32_dpp v32, v19, v6 row_newbcast:11 row_mask:0xf bank_mask:0xf
  v_and_b32_dpp v33, v19, v7 row_newbcast:11 row_mask:0xf bank_mask:0xf
  v_and_b32_dpp v34, v19, v8 row_newbcast:11 row_mask:0xf bank_mask:0xf
  v_and_b32_dpp v35, v19, v9 row_newbcast:11 row_mask:0xf bank_mask:0xf
  s_waitcnt vmcnt(8)
  buffer_load_dwordx4 v[132:135], v1, s[44:47], s14 offen offset:1024 nt
  v_mfma_f32_16x16x32_bf16 v[24:27], v[28:31], v[96:99], v[24:27]
  v_and_b32_dpp v28, v19, v6 row_newbcast:7 row_mask:0xf bank_mask:0xf
  v_and_b32_dpp v29, v19, v7 row_newbcast:7 row_mask:0xf bank_mask:0xf
  v_and_b32_dpp v30, v19, v8 row_newbcast:7 row_mask:0xf bank_mask:0xf
  v_and_b32_dpp v31, v19, v9 row_newbcast:7 row_mask:0xf bank_mask:0xf
  s_waitcnt vmcnt(8)
  buffer_load_dwordx4 v[136:139], v1, s[44:47], s14 offen offset:2048 nt
  v_mfma_f32_16x16x32_bf16 v[24:27], v[32:35], v[100:103], v[24:27]
  v_and_b32_dpp v32, v19, v6 row_newbcast:15 row_mask:0xf bank_mask:0xf
  v_and_b32_dpp v33, v19, v7 row_newbcast:15 row_mask:0xf bank_mask:0xf
  v_and_b32_dpp v34, v19, v8 row_newbcast:15 row_mask:0xf bank_mask:0xf
  v_and_b32_dpp v35, v19, v9 row_newbcast:15 row_mask:0xf bank_mask:0xf
  s_waitcnt vmcnt(8)
  buffer_load_dwordx4 v[140:143], v1, s[44:47], s14 offen offset:3072 nt
  v_mfma_f32_16x16x32_bf16 v[24:27], v[28:31], v[104:107], v[24:27]
  v_and_b32_dpp v28, v20, v6 row_newbcast:0 row_mask:0xf bank_mask:0xf
  v_and_b32_dpp v29, v20, v7 row_newbcast:0 row_mask:0xf bank_mask:0xf
  v_and_b32_dpp v30, v20, v8 row_newbcast:0 row_mask:0xf bank_mask:0xf
  v_and_b32_dpp v31, v20, v9 row_newbcast:0 row_mask:0xf bank_mask:0xf
  s_waitcnt vmcnt(8)
  s_add_u32 s14, s14, s15
  buffer_load_dwordx4 v[144:147], v1, s[44:47], s14 offen nt
  v_mfma_f32_16x16x32_bf16 v[24:27], v[32:35], v[108:111], v[24:27]
  v_and_b32_dpp v32, v20, v6 row_newbcast:8 row_mask:0xf bank_mask:0xf
  v_and_b32_dpp v33, v20, v7 row_newbcast:8 row_mask:0xf bank_mask:0xf
  v_and_b32_dpp v34, v20, v8 row_newbcast:8 row_mask:0xf bank_mask:0xf
  v_and_b32_dpp v35, v20, v9 row_newbcast:8 row_mask:0xf bank_mask:0xf
  s_waitcnt vmcnt(8)
  buffer_load_dwordx4 v[148:151], v1, s[44:47], s14 offen offset:1024 nt
  v_mfma_f32_16x16x32_bf16 v[24:27], v[28:31], v[112:115], v[24:27]
  v_and_b32_dpp v28, v20, v6 row_newbcast:4 row_mask:0xf bank_mask:0xf
  v_and_b32_dpp v29, v20, v7 row_newbcast:4 row_mask:0xf bank_mask:0xf
  v_and_b32_dpp v30, v20, v8 row_newbcast:4 row_mask:0xf bank_mask:0xf
  v_and_b32_dpp v31, v20, v9 row_newbcast:4 row_mask:0xf bank_mask:0xf
  s_waitcnt vmcnt(8)
  buffer_load_dwordx4 v[152:155], v1, s[44:47], s14 offen offset:2048 nt
  v_mfma_f32_16x16x32_bf16 v[24:27], v[32:35], v[116:119], v[24:27]
  v_and_b32_dpp v32, v20, v6 row_newbcast:12 row_mask:0xf bank_mask:0xf
  v_and_b32_dpp v33, v20, v7 row_newbcast:12 row_mask:0xf bank_mask:0xf
  v_and_b32_dpp v34, v20, v8 row_newbcast:12 row_mask:0xf bank_mask:0xf
  v_and_b32_dpp v35, v20, v9 row_newbcast:12 row_mask:0xf bank_mask:0xf
  s_waitcnt vmcnt(8)
  buffer_load_dwordx4 v[156:159], v1, s[44:47], s14 offen offset:3072 nt
  v_mfma_f32_16x16x32_bf16 v[24:27], v[28:31], v[120:123], v[24:27]
  v_and_b32_dpp v28, v20, v6 row_newbcast:1 row_mask:0xf bank_mask:0xf
  v_and_b32_dpp v29, v20, v7 row_newbcast:1 row_mask:0xf bank_mask:0xf
  v_and_b32_dpp v30, v20, v8 row_newbcast:1 row_mask:0xf bank_mask:0xf
  v_and_b32_dpp v31, v20, v9 row_newbcast:1 row_mask:0xf bank_mask:0xf
  s_waitcnt vmcnt(8)
  v_mfma_f32_16x16x32_bf16 v[24:27], v[32:35], v[124:127], v[24:27]
  v_and_b32_dpp v32, v20, v6 row_newbcast:9 row_mask:0xf bank_mask:0xf
  v_and_b32_dpp v33, v20, v7 row_newbcast:9 row_mask:0xf bank_mask:0xf
  v_and_b32_dpp v34, v20, v8 row_newbcast:9 row_mask:0xf bank_mask:0xf
  v_and_b32_dpp v35, v20, v9 row_newbcast:9 row_mask:0xf bank_mask:0xf
  s_waitcnt vmcnt(7)
  v_mfma_f32_16x16x32_bf16 v[24:27], v[28:31], v[128:131], v[24:27]
  v_and_b32_dpp v28, v20, v6 row_newbcast:5 row_mask:0xf bank_mask:0xf
  v_and_b32_dpp v29, v20, v7 row_newbcast:5 row_mask:0xf bank_mask:0xf
  v_and_b32_dpp v30, v20, v8 row_newbcast:5 row_mask:0xf bank_mask:0xf
  v_and_b32_dpp v31, v20, v9 row_newbcast:5 row_mask:0xf bank_mask:0xf
  s_waitcnt vmcnt(6)
  v_mfma_f32_16x16x32_bf16 v[24:27], v[32:35], v[132:135], v[24:27]
  v_and_b32_dpp v32, v20, v6 row_newbcast:13 row_mask:0xf bank_mask:0xf
  v_and_b32_dpp v33, v20, v7 row_newbcast:13 row_mask:0xf bank_mask:0xf
  v_and_b32_dpp v34, v20, v8 row_newbcast:13 row_mask:0xf bank_mask:0xf
  v_and_b32_dpp v35, v20, v9 row_newbcast:13 row_mask:0xf bank_mask:0xf
  s_waitcnt vmcnt(5)
  v_mfma_f32_16x16x32_bf16 v[24:27], v[28:31], v[136:139], v[24:27]
  v_and_b32_dpp v28, v20, v6 row_newbcast:2 row_mask:0xf bank_mask:0xf
  v_and_b32_dpp v29, v20, v7 row_newbcast:2 row_mask:0xf bank_mask:0xf
  v_and_b32_dpp v30, v20, v8 row_newbcast:2 row_mask:0xf bank_mask:0xf
  v_and_b32_dpp v31, v20, v9 row_newbcast:2 row_mask:0xf bank_mask:0xf
  s_waitcnt vmcnt(4)
  v_mfma_f32_16x16x32_bf16 v[24:27], v[32:35], v[140:143], v[24:27]
  v_and_b32_dpp v32, v20, v6 row_newbcast:10 row_mask:0xf bank_mask:0xf
  v_and_b32_dpp v33, v20, v7 row_newbcast:10 row_mask:0xf bank_mask:0xf
  v_and_b32_dpp v34, v20, v8 row_newbcast:10 row_mask:0xf bank_mask:0xf
  v_and_b32_dpp v35, v20, v9 row_newbcast:10 row_mask:0xf bank_mask:0xf
  s_waitcnt vmcnt(3)
  v_mfma_f32_16x16x32_bf16 v[24:27], v[28:31], v[144:147], v[24:27]
  v_and_b32_dpp v28, v20, v6 row_newbcast:6 row_mask:0xf bank_mask:0xf
  v_and_b32_dpp v29, v20, v7 row_newbcast:6 row_mask:0xf bank_mask:0xf
  v_and_b32_dpp v30, v20, v8 row_newbcast:6 row_mask:0xf bank_mask:0xf
  v_and_b32_dpp v31, v20, v9 row_newbcast:6 row_mask:0xf bank_mask:0xf
  s_waitcnt vmcnt(2)
  v_mfma_f32_16x16x32_bf16 v[24:27], v[32:35], v[148:151], v[24:27]
  v_and_b32_dpp v32, v20, v6 row_newbcast:14 row_mask:0xf bank_mask:0xf
  v_and_b32_dpp v33, v20, v7 row_newbcast:14 row_mask:0xf bank_mask:0xf
  v_and_b32_dpp v34, v20, v8 row_newbcast:14 row_mask:0xf bank_mask:0xf
  v_and_b32_dpp v35, v20, v9 row_newbcast:14 row_mask:0xf bank_mask:0xf
  s_waitcnt vmcnt(1)
  v_mfma_f32_16x16x32_bf16 v[24:27], v[28:31], v[152:155], v[24:27]
  s_waitcnt vmcnt(0)
  v_mfma_f32_16x16x32_bf16 v[24:27], v[32:35], v[156:159], v[24:27]
  s_mov_b32 exec_hi, 0
  s_nop 6
  ds_write_b128 v50, v[24:27] offset:512
  s_waitcnt lgkmcnt(0)
  s_barrier
L_exit:
  s_endpgm
L_shelper:
  s_cmp_eq_u32 s3, 5
  s_cbranch_scc0 L_notlb
  s_lshl_b32 s11, s8, 21
  s_add_u32 s42, s11, 0x200000
  s_mul_i32 s12, s5, 704512
  s_add_u32 s11, s11, s12
  v_lshlrev_b32 v1, 21, v0
  v_min_u32 v1, 688000, v1
  v_add_u32 v1, s11, v1
  s_mov_b32 s43, 0x20000
  s_mov_b64 exec, 0x1
  s_waitcnt lgkmcnt(0)
  s_mov_b32 s40, s20
  s_mov_b32 s41, s21
  buffer_load_dword v2, v1, s[40:43], 0 offen nt
  s_endpgm
L_notlb:
  s_cmp_eq_u32 s3, 4
  s_cbranch_scc0 L_exit
  s_setprio 3
  v_mov_b32 v60, -1
  v_lshlrev_b32 v3, 2, v0
  s_mov_b64 exec, 0xff
  ds_write_b32 v3, v60 offset:256
  s_mov_b64 exec, -1
  s_waitcnt lgkmcnt(0)
  s_load_dwordx2 s[36:37], s[38:39], 0
  s_mov_b32 s48, s38
  s_mov_b32 s49, s39
  s_mov_b32 s50, 0x200000
  s_mov_b32 s51, 0x20000
  s_mov_b32 s33, 0x40000
  s_and_b32 s7, s8, 31
  s_lshr_b32 s6, s8, 5
  s_lshl_b32 s9, s6, 2
  s_add_u32 s9, s9, s5
  s_lshl_b32 s10, s7, 3
  s_add_u32 s10, s10, s9
  s_mul_i32 s10, s10, 640
  s_add_u32 s10, s10, 0x10000
  v_lshl_add_u32 v59, v0, 4, s10
  v_lshlrev_b32 v58, 4, v0
  s_lshl_b32 s10, s8, 9
  s_add_u32 s10, s10, 0x1000
  v_lshl_add_u32 v3, v0, 4, s10
  v_lshlrev_b32 v12, 3, v0
  s_waitcnt lgkmcnt(0)
  s_mul_i32 s70, s37, 0x4c957f2d
  s_mul_i32 s71, s36, 0x5851f42d
  s_add_u32 s70, s70, s71
  s_mul_hi_u32 s71, s36, 0x4c957f2d
  s_add_u32 s70, s70, s71
  s_mul_i32 s36, s36, 0x4c957f2d
  s_add_u32 s36, s36, 0xf767814f
  s_addc_u32 s37, s70, 0x14057b7e
  s_mov_b32 exec_hi, 0
  s_mov_b32 s70, 0
  s_mov_b32 s15, 0
L_ptag_1:
  buffer_load_dwordx4 v[4:7], v3, s[48:51], s15 offen sc1
  s_add_u32 s70, s70, 1
  s_and_b32 s71, s70, 3
  s_cselect_b32 s15, 0, 0x40000
  s_waitcnt vmcnt(0)
  v_cmp_ne_u64 vcc, s[36:37], v[6:7]
  s_cbranch_vccz L_ptagd_2
  s_mov_b64 exec, vcc
  s_sleep 8
  s_cmp_lt_u32 s70, 40000
  s_cbranch_scc1 L_ptag_1
L_ptagd_2:
  s_mov_b64 exec, -1
  s_mov_b32 exec_hi, 0
  ds_write_b64 v12, v[4:5] offset:0
  s_mov_b64 exec, -1
  s_waitcnt lgkmcnt(0)
  s_barrier
  v_and_b32 v3, 3, v0
  v_lshlrev_b32 v3, 3, v3
  s_mov_b32 s70, 0
L_ml_3:
  ds_read_b64 v[4:5], v3 offset:256
  s_waitcnt lgkmcnt(0)
  v_max_u32 v6, v4, v5
  v_cmp_eq_u32 vcc, -1, v6
  s_cbranch_vccz L_mld_4
  s_add_u32 s70, s70, 1
  s_sleep 32
  s_cmp_lt_u32 s70, 40000
  s_cbranch_scc1 L_ml_3
L_mld_4:
  v_max_f32_dpp v40, v4, v4 quad_perm:[1,0,3,2] row_mask:0xf bank_mask:0xf
  s_nop 1
  v_max_f32_dpp v40, v40, v40 quad_perm:[2,3,0,1] row_mask:0xf bank_mask:0xf
  v_sub_f32 v4, v4, v40
  v_mul_f32 v4, 0x3fb8aa3b, v4
  v_exp_f32 v4, v4
  s_nop 0
  v_mul_f32 v41, v5, v4
  s_nop 1
  v_add_f32_dpp v41, v41, v41 quad_perm:[1,0,3,2] row_mask:0xf bank_mask:0xf
  s_nop 1
  v_add_f32_dpp v41, v41, v41 quad_perm:[2,3,0,1] row_mask:0xf bank_mask:0xf
  v_mov_b32 v42, s36
  v_mov_b32 v43, s37
  v_readlane_b32 s52, v4, 0
  v_readlane_b32 s53, v4, 0
  v_readlane_b32 s54, v4, 1
  v_readlane_b32 s55, v4, 1
  v_readlane_b32 s56, v4, 2
  v_readlane_b32 s57, v4, 2
  v_readlane_b32 s58, v4, 3
  v_readlane_b32 s59, v4, 3
  s_mov_b32 exec_lo, 0
  s_mov_b32 exec_hi, 1
  buffer_store_dwordx4 v[40:43], v59, s[48:51], 0 offen
  s_mov_b32 s34, 1
  s_mov_b64 exec, 0xff
  s_lshl_b32 s10, s4, 7
  s_add_u32 s10, s10, 0xa000
  v_lshl_add_u32 v3, v0, 4, s10
  buffer_load_dwordx4 v[8:11], v3, s[48:51], 0 offen sc1
  s_getreg_b32 s10, hwreg(HW_REG_XCC_ID)
  s_waitcnt vmcnt(0)
  v_cmp_ne_u64 vcc, s[36:37], v[10:11]
  v_cmp_ne_u32 s[66:67], s10, v8
  s_nop 0
  s_or_b64 vcc, vcc, s[66:67]
  s_cselect_b32 s34, 1, 0
  s_cmp_eq_u32 s34, 0
  s_cbranch_scc1 L_hnoslow0
  s_mov_b32 exec_lo, 0
  s_mov_b32 exec_hi, 1
  buffer_store_dwordx4 v[40:43], v59, s[48:51], s33 offen sc1
L_hnoslow0:
  s_mov_b32 s68, 0xaaaaaaaa
  s_mov_b32 s69, 0xaaaaaaaa
  s_mov_b32 s50, 0
  s_branch L_hcomb
L_hreal:
  s_mov_b32 s50, 0x200000
  s_barrier
L_hcomb:
  s_mov_b32 exec_lo, -1
  s_mov_b32 exec_hi, 0
  ds_read_b128 v[4:7], v58 offset:512
  ds_read_b128 v[8:11], v58 offset:1024
  ds_read_b128 v[12:15], v58 offset:1536
  ds_read_b128 v[16:19], v58 offset:2048
  s_waitcnt lgkmcnt(3)
  v_pk_mul_f32 v[4:5], v[4:5], s[52:53]
  v_pk_mul_f32 v[6:7], v[6:7], s[52:53]
  s_waitcnt lgkmcnt(2)
  v_pk_fma_f32 v[4:5], v[8:9], s[54:55], v[4:5]
  v_pk_fma_f32 v[6:7], v[10:11], s[54:55], v[6:7]
  s_waitcnt lgkmcnt(1)
  v_pk_fma_f32 v[4:5], v[12:13], s[56:57], v[4:5]
  v_pk_fma_f32 v[6:7], v[14:15], s[56:57], v[6:7]
  s_waitcnt lgkmcnt(0)
  v_pk_fma_f32 v[4:5], v[16:17], s[58:59], v[4:5]
  v_pk_fma_f32 v[6:7], v[18:19], s[58:59], v[6:7]
  v_cvt_pk_bf16_f32 v8, v4, v5
  v_cvt_pk_bf16_f32 v9, v6, v7
  v_cndmask_b32 v20, v42, v8, s[68:69]
  v_cndmask_b32 v21, v43, v9, s[68:69]
  v_cndmask_b32 v22, v8, v42, s[68:69]
  v_cndmask_b32 v23, v9, v43, s[68:69]
  buffer_store_dwordx4 v[20:23], v59, s[48:51], 0 offen
  s_cmp_eq_u32 s34, 0
  s_cbranch_scc1 L_hnoslow
  buffer_store_dwordx4 v[20:23], v59, s[48:51], s33 offen sc1
L_hnoslow:
  s_cmp_eq_u32 s50, 0
  s_cbranch_scc1 L_hreal
  s_endpgm
L_service:
  s_lshr_b32 s5, s2, 3
  v_and_b32 v1, 15, v0
  v_lshrrev_b32 v2, 4, v0
  s_lshr_b32 s7, s5, 1
  s_lshl_b32 s7, s7, 3
  s_add_u32 s7, s7, s4
  s_and_b32 s6, s5, 1
  s_lshl_b32 s10, s3, 19
  s_lshl_b32 s11, s7, 8
  s_add_u32 s10, s10, s11
  s_lshl_b32 s11, s6, 7
  s_add_u32 s10, s10, s11
  v_lshlrev_b32 v3, 16, v2
  v_lshl_add_u32 v3, v1, 3, v3
  v_add_u32 v3, s10, v3
  v_lshlrev_b32 v20, 4, v0
  v_and_b32 v21, 1, v0
  v_lshlrev_b32 v21, 10, v21
  v_lshl_add_u32 v21, v2, 4, v21
  s_lshl_b32 s10, s3, 7
  v_add_u32 v21, s10, v21
  s_mov_b32 s58, 2048
  s_mov_b32 s59, 0x20000
  s_mov_b32 s42, 0x400000
  s_mov_b32 s43, 0x20000
  s_waitcnt lgkmcnt(0)
  s_mov_b32 s56, s16
  s_mov_b32 s57, s17
  s_mov_b32 s40, s22
  s_mov_b32 s41, s23
  buffer_load_dwordx4 v[4:7], v20, s[56:59], 0 offen
  buffer_load_dwordx4 v[8:11], v20, s[56:59], 0 offen offset:1024
  buffer_load_dwordx4 v[12:15], v21, s[56:59], 0 offen
  buffer_load_dwordx4 v[16:19], v21, s[56:59], 0 offen offset:64
  s_mov_b32 s14, 0x0
  buffer_load_dwordx2 v[192:193], v3, s[40:43], s14 offen nt
  s_mov_b32 s14, 0x2000
  buffer_load_dwordx2 v[194:195], v3, s[40:43], s14 offen nt
  s_mov_b32 s14, 0x4000
  buffer_load_dwordx2 v[196:197], v3, s[40:43], s14 offen nt
  s_mov_b32 s14, 0x6000
  buffer_load_dwordx2 v[198:199], v3, s[40:43], s14 offen nt
  s_mov_b32 s14, 0x8000
  buffer_load_dwordx2 v[200:201], v3, s[40:43], s14 offen nt
  s_mov_b32 s14, 0xa000
  buffer_load_dwordx2 v[202:203], v3, s[40:43], s14 offen nt
  s_mov_b32 s14, 0xc000
  buffer_load_dwordx2 v[204:205], v3, s[40:43], s14 offen nt
  s_mov_b32 s14, 0xe000
  buffer_load_dwordx2 v[206:207], v3, s[40:43], s14 offen nt
  s_mov_b32 s14, 0x40000
  buffer_load_dwordx2 v[208:209], v3, s[40:43], s14 offen nt
  s_mov_b32 s14, 0x42000
  buffer_load_dwordx2 v[210:211], v3, s[40:43], s14 offen nt
  s_mov_b32 s14, 0x44000
  buffer_load_dwordx2 v[212:213], v3, s[40:43], s14 offen nt
  s_mov_b32 s14, 0x46000
  buffer_load_dwordx2 v[214:215], v3, s[40:43], s14 offen nt
  s_mov_b32 s14, 0x48000
  buffer_load_dwordx2 v[216:217], v3, s[40:43], s14 offen nt
  s_mov_b32 s14, 0x4a000
  buffer_load_dwordx2 v[218:219], v3, s[40:43], s14 offen nt
  s_mov_b32 s14, 0x4c000
  buffer_load_dwordx2 v[220:221], v3, s[40:43], s14 offen nt
  s_mov_b32 s14, 0x4e000
  buffer_load_dwordx2 v[222:223], v3, s[40:43], s14 offen nt
  s_load_dwordx2 s[36:37], s[38:39], 0
  s_mov_b32 s48, s38
  s_mov_b32 s49, s39
  s_mov_b32 s50, 0x200000
  s_mov_b32 s51, 0x20000
  s_mov_b32 s52, s32
  s_mov_b32 s53, s33
  s_mov_b32 s54, 0x158000
  s_mov_b32 s55, 0x20000
  s_mov_b32 s33, 0x40000
  s_mov_b32 s64, 0x05040100
  s_mov_b32 s65, 0x07060302
  v_mov_b32 v52, 0
  v_mov_b32 v53, 0
  v_mov_b32 v54, 0
  v_mov_b32 v55, 0
  v_mov_b32 v56, 0
  v_mov_b32 v57, 0
  v_mov_b32 v58, 0
  v_mov_b32 v59, 0
  v_mov_b32 v60, 0
  v_mov_b32 v61, 0
  v_mov_b32 v62, 0
  v_mov_b32 v63, 0
  v_and_b32 v56, 1, v2
  v_lshlrev_b32 v56, 8, v56
  v_lshl_add_u32 v56, v1, 4, v56
  s_lshl_b32 s10, s3, 9
  v_add_u32 v56, s10, v56
  v_lshlrev_b32 v57, 3, v0
  s_lshl_b32 s10, s7, 9
  s_lshl_b32 s11, s6, 8
  s_add_u32 s10, s10, s11
  s_add_u32 s10, s10, 0x1000
  v_lshlrev_b32 v58, 14, v2
  v_lshl_add_u32 v58, v1, 4, v58
  v_add_u32 v58, s10, v58
  s_waitcnt vmcnt(18)
  v_lshlrev_b32 v20, 16, v4
  v_and_b32 v21, 0xffff0000, v4
  v_lshlrev_b32 v22, 16, v5
  v_and_b32 v23, 0xffff0000, v5
  v_lshlrev_b32 v24, 16, v6
  v_and_b32 v25, 0xffff0000, v6
  v_lshlrev_b32 v26, 16, v7
  v_and_b32 v27, 0xffff0000, v7
  v_lshlrev_b32 v28, 16, v8
  v_and_b32 v29, 0xffff0000, v8
  v_lshlrev_b32 v30, 16, v9
  v_and_b32 v31, 0xffff0000, v9
  v_lshlrev_b32 v32, 16, v10
  v_and_b32 v33, 0xffff0000, v10
  v_lshlrev_b32 v34, 16, v11
  v_and_b32 v35, 0xffff0000, v11
  v_add_f32 v36, v20, v21
  v_add_f32 v38, v22, v23
  v_add_f32 v36, v36, v24
  v_add_f32 v38, v38, v25
  v_add_f32 v36, v36, v26
  v_add_f32 v38, v38, v27
  v_add_f32 v36, v36, v38
  v_add_f32 v37, v28, v29
  v_add_f32 v39, v30, v31
  v_add_f32 v37, v37, v32
  v_add_f32 v39, v39, v33
  v_add_f32 v37, v37, v34
  v_add_f32 v39, v39, v35
  v_add_f32 v37, v37, v39
  v_add_f32_dpp v36, v36, v36 row_ror:8 row_mask:0xf bank_mask:0xf
  s_nop 0
  v_add_f32_dpp v37, v37, v37 row_ror:8 row_mask:0xf bank_mask:0xf
  v_add_f32_dpp v36, v36, v36 row_ror:4 row_mask:0xf bank_mask:0xf
  s_nop 0
  v_add_f32_dpp v37, v37, v37 row_ror:4 row_mask:0xf bank_mask:0xf
  v_add_f32_dpp v36, v36, v36 row_ror:2 row_mask:0xf bank_mask:0xf
  s_nop 0
  v_add_f32_dpp v37, v37, v37 row_ror:2 row_mask:0xf bank_mask:0xf
  v_add_f32_dpp v36, v36, v36 row_ror:1 row_mask:0xf bank_mask:0xf
  s_nop 0
  v_add_f32_dpp v37, v37, v37 row_ror:1 row_mask:0xf bank_mask:0xf
  v_mov_b32 v38, v36
  v_mov_b32 v39, v37
  s_nop 0
  v_permlane16_swap_b32 v36, v38
  v_permlane16_swap_b32 v37, v39
  v_add_f32 v36, v36, v38
  v_add_f32 v37, v37, v39
  v_mov_b32 v38, v36
  v_mov_b32 v39, v37
  s_nop 0
  v_permlane32_swap_b32 v36, v38
  v_permlane32_swap_b32 v37, v39
  v_add_f32 v36, v36, v38
  v_add_f32 v37, v37, v39
  v_mul_f32 v36, 0x3b000000, v36
  v_mul_f32 v37, 0x3b000000, v37
  v_sub_f32 v20, v20, v36
  v_sub_f32 v21, v21, v36
  v_sub_f32 v22, v22, v36
  v_sub_f32 v23, v23, v36
  v_sub_f32 v24, v24, v36
  v_sub_f32 v25, v25, v36
  v_sub_f32 v26, v26, v36
  v_sub_f32 v27, v27, v36
  v_sub_f32 v28, v28, v37
  v_sub_f32 v29, v29, v37
  v_sub_f32 v30, v30, v37
  v_sub_f32 v31, v31, v37
  v_sub_f32 v32, v32, v37
  v_sub_f32 v33, v33, v37
  v_sub_f32 v34, v34, v37
  v_sub_f32 v35, v35, v37
  v_mul_f32 v40, v20, v20
  v_mul_f32 v41, v28, v28
  v_fmac_f32 v40, v21, v21
  v_fmac_f32 v41, v29, v29
  v_fmac_f32 v40, v22, v22
  v_fmac_f32 v41, v30, v30
  v_fmac_f32 v40, v23, v23
  v_fmac_f32 v41, v31, v31
  v_fmac_f32 v40, v24, v24
  v_fmac_f32 v41, v32, v32
  v_fmac_f32 v40, v25, v25
  v_fmac_f32 v41, v33, v33
  v_fmac_f32 v40, v26, v26
  v_fmac_f32 v41, v34, v34
  v_fmac_f32 v40, v27, v27
  v_fmac_f32 v41, v35, v35
  s_nop 0
  v_add_f32_dpp v40, v40, v40 row_ror:8 row_mask:0xf bank_mask:0xf
  v_add_f32_dpp v41, v41, v41 row_ror:8 row_mask:0xf bank_mask:0xf
  s_nop 0
  v_add_f32_dpp v40, v40, v40 row_ror:4 row_mask:0xf bank_mask:0xf
  v_add_f32_dpp v41, v41, v41 row_ror:4 row_mask:0xf bank_mask:0xf
  s_nop 0
  v_add_f32_dpp v40, v40, v40 row_ror:2 row_mask:0xf bank_mask:0xf
  v_add_f32_dpp v41, v41, v41 row_ror:2 row_mask:0xf bank_mask:0xf
  s_nop 0
  v_add_f32_dpp v40, v40, v40 row_ror:1 row_mask:0xf bank_mask:0xf
  v_add_f32_dpp v41, v41, v41 row_ror:1 row_mask:0xf bank_mask:0xf
  v_mov_b32 v38, v40
  v_mov_b32 v39, v41
  s_nop 0
  v_permlane16_swap_b32 v40, v38
  v_permlane16_swap_b32 v41, v39
  v_add_f32 v40, v40, v38
  v_add_f32 v41, v41, v39
  v_mov_b32 v38, v40
  v_mov_b32 v39, v41
  s_nop 0
  v_permlane32_swap_b32 v40, v38
  v_permlane32_swap_b32 v41, v39
  v_add_f32 v40, v40, v38
  v_add_f32 v41, v41, v39
  s_mov_b32 s66, 0xaaaaaaaa
  s_mov_b32 s67, 0xaaaaaaaa
  v_cndmask_b32 v36, v36, v37, s[66:67]
  v_cndmask_b32 v40, v40, v41, s[66:67]
  v_mul_f32 v40, 0x3b000000, v40
  v_cvt_pk_bf16_f32 v40, v40, v40
  v_and_b32 v40, 0xffff0000, v40
  v_cvt_pk_bf16_f32 v36, v36, v36
  v_and_b32 v36, 0xffff0000, v36
  v_add_f32 v40, 0x3727c5ac, v40
  v_cvt_pk_bf16_f32 v40, v40, v40
  v_and_b32 v40, 0xffff0000, v40
  v_sqrt_f32 v40, v40
  s_nop 0
  v_cvt_pk_bf16_f32 v40, v40, v40
  v_and_b32 v40, 0xffff0000, v40
  v_rcp_f32 v40, v40
  s_waitcnt vmcnt(16)
  v_lshlrev_b32 v20, 16, v12
  v_and_b32 v21, 0xffff0000, v12
  v_lshlrev_b32 v22, 16, v13
  v_and_b32 v23, 0xffff0000, v13
  v_lshlrev_b32 v24, 16, v14
  v_and_b32 v25, 0xffff0000, v14
  v_lshlrev_b32 v26, 16, v15
  v_and_b32 v27, 0xffff0000, v15
  v_lshlrev_b32 v28, 16, v16
  v_and_b32 v29, 0xffff0000, v16
  v_lshlrev_b32 v30, 16, v17
  v_and_b32 v31, 0xffff0000, v17
  v_lshlrev_b32 v32, 16, v18
  v_and_b32 v33, 0xffff0000, v18
  v_lshlrev_b32 v34, 16, v19
  v_and_b32 v35, 0xffff0000, v19
  v_sub_f32 v20, v20, v36
  v_sub_f32 v21, v21, v36
  v_sub_f32 v22, v22, v36
  v_sub_f32 v23, v23, v36
  v_sub_f32 v24, v24, v36
  v_sub_f32 v25, v25, v36
  v_sub_f32 v26, v26, v36
  v_sub_f32 v27, v27, v36
  v_sub_f32 v28, v28, v36
  v_sub_f32 v29, v29, v36
  v_sub_f32 v30, v30, v36
  v_sub_f32 v31, v31, v36
  v_sub_f32 v32, v32, v36
  v_sub_f32 v33, v33, v36
  v_sub_f32 v34, v34, v36
  v_sub_f32 v35, v35, v36
  v_cvt_pk_bf16_f32 v4, v20, v21
  v_cvt_pk_bf16_f32 v5, v22, v23
  v_cvt_pk_bf16_f32 v6, v24, v25
  v_cvt_pk_bf16_f32 v7, v26, v27
  v_cvt_pk_bf16_f32 v8, v28, v29
  v_cvt_pk_bf16_f32 v9, v30, v31
  v_cvt_pk_bf16_f32 v10, v32, v33
  v_cvt_pk_bf16_f32 v11, v34, v35
  v_lshlrev_b32 v20, 16, v4
  v_and_b32 v21, 0xffff0000, v4
  v_lshlrev_b32 v22, 16, v5
  v_and_b32 v23, 0xffff0000, v5
  v_lshlrev_b32 v24, 16, v6
  v_and_b32 v25, 0xffff0000, v6
  v_lshlrev_b32 v26, 16, v7
  v_and_b32 v27, 0xffff0000, v7
  v_lshlrev_b32 v28, 16, v8
  v_and_b32 v29, 0xffff0000, v8
  v_lshlrev_b32 v30, 16, v9
  v_and_b32 v31, 0xffff0000, v9
  v_lshlrev_b32 v32, 16, v10
  v_and_b32 v33, 0xffff0000, v10
  v_lshlrev_b32 v34, 16, v11
  v_and_b32 v35, 0xffff0000, v11
  v_mul_f32 v20, v20, v40
  v_mul_f32 v21, v21, v40
  v_mul_f32 v22, v22, v40
  v_mul_f32 v23, v23, v40
  v_mul_f32 v24, v24, v40
  v_mul_f32 v25, v25, v40
  v_mul_f32 v26, v26, v40
  v_mul_f32 v27, v27, v40
  v_mul_f32 v28, v28, v40
  v_mul_f32 v29, v29, v40
  v_mul_f32 v30, v30, v40
  v_mul_f32 v31, v31, v40
  v_mul_f32 v32, v32, v40
  v_mul_f32 v33, v33, v40
  v_mul_f32 v34, v34, v40
  v_mul_f32 v35, v35, v40
  v_cvt_pk_bf16_f32 v12, v20, v21
  v_cvt_pk_bf16_f32 v13, v22, v23
  v_cvt_pk_bf16_f32 v14, v24, v25
  v_cvt_pk_bf16_f32 v15, v26, v27
  v_cvt_pk_bf16_f32 v16, v28, v29
  v_cvt_pk_bf16_f32 v17, v30, v31
  v_cvt_pk_bf16_f32 v18, v32, v33
  v_cvt_pk_bf16_f32 v19, v34, v35
  s_waitcnt lgkmcnt(0)
  s_mul_i32 s70, s37, 0x4c957f2d
  s_mul_i32 s71, s36, 0x5851f42d
  s_add_u32 s70, s70, s71
  s_mul_hi_u32 s71, s36, 0x4c957f2d
  s_add_u32 s70, s70, s71
  s_mul_i32 s36, s36, 0x4c957f2d
  s_add_u32 s36, s36, 0xf767814f
  s_addc_u32 s37, s70, 0x14057b7e
  s_waitcnt vmcnt(8)
  v_perm_b32 v64, v194, v192, s64
  v_perm_b32 v65, v198, v196, s64
  v_perm_b32 v66, v202, v200, s64
  v_perm_b32 v67, v206, v204, s64
  v_perm_b32 v68, v194, v192, s65
  v_perm_b32 v69, v198, v196, s65
  v_perm_b32 v70, v202, v200, s65
  v_perm_b32 v71, v206, v204, s65
  v_perm_b32 v72, v195, v193, s64
  v_perm_b32 v73, v199, v197, s64
  v_perm_b32 v74, v203, v201, s64
  v_perm_b32 v75, v207, v205, s64
  v_perm_b32 v76, v195, v193, s65
  v_perm_b32 v77, v199, v197, s65
  v_perm_b32 v78, v203, v201, s65
  v_perm_b32 v79, v207, v205, s65
  v_mfma_f32_16x16x32_bf16 v[20:23], v[12:15], v[64:67], 0
  v_mfma_f32_16x16x32_bf16 v[24:27], v[12:15], v[68:71], 0
  v_mfma_f32_16x16x32_bf16 v[28:31], v[12:15], v[72:75], 0
  v_mfma_f32_16x16x32_bf16 v[32:35], v[12:15], v[76:79], 0
  s_waitcnt vmcnt(0)
  v_perm_b32 v80, v210, v208, s64
  v_perm_b32 v81, v214, v212, s64
  v_perm_b32 v82, v218, v216, s64
  v_perm_b32 v83, v222, v220, s64
  v_perm_b32 v84, v210, v208, s65
  v_perm_b32 v85, v214, v212, s65
  v_perm_b32 v86, v218, v216, s65
  v_perm_b32 v87, v222, v220, s65
  v_perm_b32 v88, v211, v209, s64
  v_perm_b32 v89, v215, v213, s64
  v_perm_b32 v90, v219, v217, s64
  v_perm_b32 v91, v223, v221, s64
  v_perm_b32 v92, v211, v209, s65
  v_perm_b32 v93, v215, v213, s65
  v_perm_b32 v94, v219, v217, s65
  v_perm_b32 v95, v223, v221, s65
  v_mfma_f32_16x16x32_bf16 v[20:23], v[16:19], v[80:83], v[20:23]
  v_mfma_f32_16x16x32_bf16 v[24:27], v[16:19], v[84:87], v[24:27]
  v_mfma_f32_16x16x32_bf16 v[28:31], v[16:19], v[88:91], v[28:31]
  v_mfma_f32_16x16x32_bf16 v[32:35], v[16:19], v[92:95], v[32:35]
  v_and_b32 v4, 1, v2
  v_cmp_eq_u32 vcc, 1, v4
  s_nop 2
  v_cndmask_b32 v4, v20, v21, vcc
  v_cndmask_b32 v5, v24, v25, vcc
  v_cndmask_b32 v6, v28, v29, vcc
  v_cndmask_b32 v7, v32, v33, vcc
  ds_write_b128 v56, v[4:7] offset:8192
  s_waitcnt lgkmcnt(0)
  s_barrier
  s_cmp_eq_u32 s3, 1
  s_cbranch_scc0 L_nopres
  s_getreg_b32 s10, hwreg(HW_REG_XCC_ID)
  s_lshl_b32 s11, s4, 3
  s_add_u32 s11, s11, s5
  s_lshl_b32 s11, s11, 4
  s_add_u32 s11, s11, 0xa000
  v_mov_b32 v3, s11
  v_mov_b32 v4, s10
  v_mov_b32 v5, 0
  v_mov_b32 v6, s36
  v_mov_b32 v7, s37
  s_mov_b64 exec, 1
  buffer_store_dwordx4 v[4:7], v3, s[48:51], 0 offen
  s_mov_b64 exec, -1
  s_nop 1
L_nopres:
  s_cmp_eq_u32 s3, 0
  s_cbranch_scc0 L_q_done
  v_lshlrev_b32 v3, 4, v0
  s_mov_b32 exec_hi, 0
  ds_read_b128 v[4:7], v3 offset:8192
  ds_read_b128 v[8:11], v3 offset:8704
  ds_read_b128 v[12:15], v3 offset:9216
  ds_read_b128 v[16:19], v3 offset:9728
  ds_read_b128 v[20:23], v3 offset:10240
  ds_read_b128 v[24:27], v3 offset:10752
  ds_read_b128 v[28:31], v3 offset:11264
  ds_read_b128 v[32:35], v3 offset:11776
  v_mov_b32 v42, s36
  v_mov_b32 v43, s37
  s_waitcnt lgkmcnt(6)
  v_add_f32 v4, v4, v8
  v_add_f32 v5, v5, v9
  v_add_f32 v6, v6, v10
  v_add_f32 v7, v7, v11
  s_waitcnt lgkmcnt(5)
  v_add_f32 v4, v4, v12
  v_add_f32 v5, v5, v13
  v_add_f32 v6, v6, v14
  v_add_f32 v7, v7, v15
  s_waitcnt lgkmcnt(4)
  v_add_f32 v4, v4, v16
  v_add_f32 v5, v5, v17
  v_add_f32 v6, v6, v18
  v_add_f32 v7, v7, v19
  s_waitcnt lgkmcnt(3)
  v_add_f32 v4, v4, v20
  v_add_f32 v5, v5, v21
  v_add_f32 v6, v6, v22
  v_add_f32 v7, v7, v23
  s_waitcnt lgkmcnt(2)
  v_add_f32 v4, v4, v24
  v_add_f32 v5, v5, v25
  v_add_f32 v6, v6, v26
  v_add_f32 v7, v7, v27
  s_waitcnt lgkmcnt(1)
  v_add_f32 v4, v4, v28
  v_add_f32 v5, v5, v29
  v_add_f32 v6, v6, v30
  v_add_f32 v7, v7, v31
  s_waitcnt lgkmcnt(0)
  v_add_f32 v4, v4, v32
  v_add_f32 v5, v5, v33
  v_add_f32 v6, v6, v34
  v_add_f32 v7, v7, v35
  v_cvt_pk_bf16_f32 v40, v4, v5
  v_cvt_pk_bf16_f32 v41, v6, v7
  buffer_store_dwordx4 v[40:43], v58, s[48:51], 0 offen
  buffer_store_dwordx4 v[40:43], v58, s[48:51], s33 offen sc1
  s_mov_b64 exec, -1
L_q_done:
  s_mul_i32 s62, s4, 5
  s_mul_i32 s10, s4, 6
  s_add_i32 s10, s10, -4
  s_cmp_lt_u32 s4, 4
  s_cselect_b32 s62, s62, s10
  s_cselect_b32 s10, 5, 6
  s_add_u32 s62, s62, s5
  s_cmp_lt_u32 s5, s10
  s_cselect_b32 s63, 1, 0
  s_cmp_lt_u32 s62, 43
  s_cselect_b32 s63, s63, 0
  s_lshr_b32 s12, s3, 1
  s_lshl_b32 s12, s12, 3
  s_add_u32 s12, s12, s4
  v_and_b32 v4, 1, v2
  v_lshlrev_b32 v6, 10, v4
  v_lshl_add_u32 v6, v1, 3, v6
  s_lshl_b32 s10, s3, 7
  v_add_u32 v6, s10, v6
  buffer_load_dwordx2 v[22:23], v6, s[56:59], 0 offen
  v_mul_u32_u24 v55, 1088, v4
  v_lshl_add_u32 v55, v1, 3, v55
  v_add_u32 v55, s10, v55
  v_mov_b32 v4, 0
  v_lshlrev_b32 v3, 2, v0
  s_mov_b64 exec, 15
  ds_write_b32 v3, v4 offset:304
  s_mov_b64 exec, -1
  s_mov_b32 s26, 0x40135761
  s_mov_b32 s27, 0x3dd2d3e8
  s_cmp_lt_u32 s3, 4
  s_cbranch_scc0 L_red_pre
  v_lshrrev_b32 v4, 3, v1
  v_mul_u32_u24 v52, 1088, v4
  v_lshl_add_u32 v52, v2, 4, v52
  v_lshlrev_b32 v61, 3, v1
  v_lshlrev_b32 v53, 6, v4
  v_lshl_add_u32 v5, v2, 4, v53
  v_add_u32 v5, 4864, v5
  v_lshl_add_u32 v53, v2, 2, v53
  s_lshl_b32 s10, s3, 4
  v_add_u32 v53, s10, v53
  v_and_b32 v6, 7, v1
  v_mov_b32 v7, 304
  v_cmp_eq_u32 vcc, 0, v6
  s_nop 1
  v_cndmask_b32 v32, v7, v5, vcc
  v_cmp_eq_u32 vcc, 1, v6
  s_nop 1
  v_cndmask_b32 v33, v7, v5, vcc
  v_cmp_eq_u32 vcc, 2, v6
  s_nop 1
  v_cndmask_b32 v34, v7, v5, vcc
  v_cmp_eq_u32 vcc, 3, v6
  s_nop 1
  v_cndmask_b32 v35, v7, v5, vcc
  v_cmp_eq_u32 vcc, 4, v6
  s_nop 1
  v_cndmask_b32 v36, v7, v5, vcc
  v_cmp_eq_u32 vcc, 5, v6
  s_nop 1
  v_cndmask_b32 v37, v7, v5, vcc
  v_cmp_eq_u32 vcc, 6, v6
  s_nop 1
  v_cndmask_b32 v38, v7, v5, vcc
  v_cmp_eq_u32 vcc, 7, v6
  s_nop 1
  v_cndmask_b32 v39, v7, v5, vcc
  v_lshlrev_b32 v7, 4, v4
  v_add_u32 v7, v2, v7
  s_lshl_b32 s10, s3, 2
  v_add_u32 v30, s10, v7
  v_lshlrev_b32 v7, 14, v30
  v_lshl_add_u32 v7, v6, 4, v7
  s_lshl_b32 s10, s62, 7
  s_add_u32 s10, s10, 0x140000
  v_add_u32 v54, s10, v7
  s_branch L_red_pre_done
L_red_pre:
  s_and_b32 s10, s2, 15
  s_lshl_b32 s10, s10, 6
  v_and_b32 v3, 7, v0
  v_lshl_add_u32 v3, v2, 3, v3
  v_lshl_add_u32 v3, v3, 1, s10
  s_bfe_u32 s11, s2, 0x10004
  s_lshl_b32 s10, s11, 10
  v_add_u32 v52, s10, v3
  s_mul_i32 s10, s11, 1088
  v_add_u32 v53, s10, v3
  s_and_b32 s10, s2, 31
  v_mov_b32 v30, s10
  s_lshl_b32 s10, s10, 14
  s_add_u32 s10, s10, 0x140000
  v_lshl_add_u32 v54, v0, 4, s10
  v_bfe_u32 v3, v0, 2, 1
  v_lshlrev_b32 v3, 4, v3
  v_mov_b32 v4, 0x3f80
  v_lshlrev_b32 v4, v3, v4
  v_and_b32 v5, 11, v0
  v_cmp_eq_u32 vcc, 0, v5
  s_nop 1
  v_cndmask_b32 v144, 0, v4, vcc
  v_cmp_eq_u32 vcc, 8, v5
  s_nop 1
  v_cndmask_b32 v145, 0, v4, vcc
  v_cmp_eq_u32 vcc, 0, v5
  s_nop 1
  v_cndmask_b32 v146, 0, v4, vcc
  v_cmp_eq_u32 vcc, 8, v5
  s_nop 1
  v_cndmask_b32 v147, 0, v4, vcc
L_red_pre_done:
  v_and_b32 v63, 1, v2
  v_lshlrev_b32 v63, 6, v63
  s_lshl_b32 s10, s3, 3
  v_add_u32 v63, s10, v63
  v_mov_b32 v62, 0x3f803f80
  s_mov_b32 s40, s34
  s_mov_b32 s41, s35
  s_mov_b32 s42, 0x800
  s_mov_b32 s43, 0x20000
  v_mov_b32 v3, 0
  s_mov_b64 exec, 1
  buffer_load_dword v21, v3, s[40:43], 0 offen
  s_mov_b64 exec, -1
  s_mul_i32 s10, s12, 5120
  s_add_u32 s13, s10, 0x10000
  s_and_b32 s11, s3, 1
  s_lshl_b32 s11, s11, 8
  s_add_u32 s10, s13, s11
  v_and_b32 v3, 7, v0
  v_mul_u32_u24 v3, 640, v3
  v_lshl_add_u32 v3, v2, 5, v3
  v_add_u32 v60, s10, v3
  v_and_b32 v3, 1, v2
  v_lshlrev_b32 v3, 2, v3
  v_and_b32 v4, 3, v0
  v_add_u32 v3, v3, v4
  v_mul_u32_u24 v3, 640, v3
  v_add_u32 v59, s13, v3
  s_lshr_b32 s10, s4, 1
  s_lshl_b32 s10, s10, 14
  s_and_b32 s11, s4, 1
  s_lshl_b32 s11, s11, 12
  s_add_u32 s10, s10, s11
  s_lshl_b32 s11, s5, 9
  s_add_u32 s10, s10, s11
  s_add_u32 s10, s10, 0x80000
  v_lshrrev_b32 v3, 1, v0
  v_and_b32 v4, 1, v0
  v_lshlrev_b32 v4, 13, v4
  v_lshl_add_u32 v3, v3, 4, v4
  v_add_u32 v58, s10, v3
  s_getreg_b32 s10, hwreg(HW_REG_XCC_ID)
  s_and_b32 s10, s10, 4
  s_lshl_b32 s10, s10, 11
  s_lshl_b32 s11, s3, 9
  s_add_u32 s10, s10, s11
  s_add_u32 s10, s10, 0x80000
  v_lshlrev_b32 v3, 14, v2
  v_lshl_add_u32 v3, v1, 4, v3
  v_add_u32 v47, s10, v3
  v_and_b32 v3, 1, v0
  v_lshlrev_b32 v3, 4, v3
  v_mov_b32 v4, 0x3f80
  v_lshlrev_b32 v4, v3, v4
  v_lshrrev_b32 v5, 1, v1
  v_cmp_eq_u32 vcc, 0, v5
  s_nop 1
  v_cndmask_b32 v232, 0, v4, vcc
  v_cmp_eq_u32 vcc, 1, v5
  s_nop 1
  v_cndmask_b32 v233, 0, v4, vcc
  v_cmp_eq_u32 vcc, 0, v5
  s_nop 1
  v_cndmask_b32 v234, 0, v4, vcc
  v_cmp_eq_u32 vcc, 1, v5
  s_nop 1
  v_cndmask_b32 v235, 0, v4, vcc
  v_cmp_eq_u32 vcc, 2, v5
  s_nop 1
  v_cndmask_b32 v236, 0, v4, vcc
  v_cmp_eq_u32 vcc, 3, v5
  s_nop 1
  v_cndmask_b32 v237, 0, v4, vcc
  v_cmp_eq_u32 vcc, 2, v5
  s_nop 1
  v_cndmask_b32 v238, 0, v4, vcc
  v_cmp_eq_u32 vcc, 3, v5
  s_nop 1
  v_cndmask_b32 v239, 0, v4, vcc
  s_movk_i32 s22, 4096
  v_mov_b32 v40, s36
  v_mov_b32 v41, s37
  v_mov_b32 v44, s36
  v_mov_b32 v45, s37
  v_mov_b32 v24, s36
  v_mov_b32 v25, s37
  v_mov_b32 v28, s36
  v_mov_b32 v29, s37
  s_mov_b32 s16, 0x00770077
  s_mov_b32 s17, 0x00770077
  s_mov_b32 s20, 0xffffff
  s_mov_b32 s21, 0
  s_waitcnt vmcnt(0) lgkmcnt(0)
  v_lshlrev_b32 v248, 16, v22
  v_and_b32 v249, 0xffff0000, v22
  v_lshlrev_b32 v250, 16, v23
  v_and_b32 v251, 0xffff0000, v23
  s_barrier
  s_mov_b64 s[18:19], s[36:37]
  s_mov_b64 s[36:37], 0
  s_mov_b32 s50, 0
  s_mov_b32 s42, 0
  s_branch L_tail
L_real:
  s_mov_b64 exec, -1
  s_mov_b64 s[36:37], s[18:19]
  s_mov_b32 s50, 0x200000
  s_movk_i32 s42, 2048
  s_cmp_eq_u32 s2, 63
  s_cbranch_scc0 L_noprobe
  s_and_b32 s10, s3, 1
  s_lshl_b32 s10, s10, 12
  s_bfe_u32 s11, s3, 0x10001
  s_lshl_b32 s11, s11, 14
  s_add_u32 s10, s10, s11
  s_lshr_b32 s11, s3, 2
  s_lshl_b32 s11, s11, 11
  s_add_u32 s10, s10, s11
  s_add_u32 s10, s10, 0x90000
  s_add_u32 s11, s10, 0x2000
  s_mov_b32 s6, -1
  s_mov_b32 s7, -1
  s_mov_b32 s70, 0
L_probe:
  s_memtime s[66:67]
  s_waitcnt lgkmcnt(0)
  s_load_dword s9, s[38:39], s10 glc
  s_waitcnt lgkmcnt(0)
  s_memtime s[68:69]
  s_waitcnt lgkmcnt(0)
  s_sub_u32 s8, s68, s66
  s_min_u32 s6, s6, s8
  s_memtime s[66:67]
  s_waitcnt lgkmcnt(0)
  s_load_dword s9, s[38:39], s11 glc
  s_waitcnt lgkmcnt(0)
  s_memtime s[68:69]
  s_waitcnt lgkmcnt(0)
  s_sub_u32 s8, s68, s66
  s_min_u32 s7, s7, s8
  s_add_u32 s70, s70, 1
  s_cmp_lt_u32 s70, 12
  s_cbranch_scc1 L_probe
  v_mov_b32 v4, s6
  v_mov_b32 v5, s7
  s_lshl_b32 s10, s3, 3
  v_mov_b32 v3, s10
  ds_write_b64 v3, v[4:5] offset:384
  s_waitcnt lgkmcnt(0)
  s_barrier
  s_cmp_eq_u32 s3, 0
  s_cbranch_scc0 L_noprobe
  v_and_b32 v3, 7, v0
  v_lshlrev_b32 v3, 3, v3
  ds_read_b64 v[4:5], v3 offset:384
  s_waitcnt lgkmcnt(0)
  v_sub_u32 v4, v4, v5
  s_nop 1
  v_add_u32_dpp v4, v4, v4 quad_perm:[1,0,3,2] row_mask:0xf bank_mask:0xf
  s_nop 1
  v_add_u32_dpp v4, v4, v4 quad_perm:[2,3,0,1] row_mask:0xf bank_mask:0xf
  s_nop 1
  v_add_u32_dpp v4, v4, v4 row_half_mirror row_mask:0xf bank_mask:0xf
  v_ashrrev_i32 v4, 31, v4
  s_getreg_b32 s10, hwreg(HW_REG_XCC_ID)
  s_lshl_b32 s11, s10, 11
  v_xor_b32 v4, s11, v4
  v_not_b32 v4, v4
  s_add_u32 s10, s10, 1
  v_mov_b32 v5, s10
  v_mov_b32 v6, s36
  v_mov_b32 v7, s37
  v_mov_b32 v3, 0xb000
  s_mov_b64 exec, 1
  buffer_store_dwordx4 v[4:7], v3, s[48:51], 0 offen sc1
  s_mov_b64 exec, -1
  s_nop 1
L_noprobe:
  s_cmp_eq_u32 s63, 0
  s_cbranch_scc1 L_ph2
  v_lshrrev_b32 v3, 2, v0
  v_mul_u32_u24 v3, 2752, v3
  v_and_b32 v4, 3, v0
  v_lshl_add_u32 v3, v4, 4, v3
  s_lshl_b32 s11, s62, 6
  v_add_u32 v3, s11, v3
  s_mov_b32 s44, s30
  s_mov_b32 s45, s31
  s_mov_b32 s46, 0x158000
  s_mov_b32 s47, 0x20000
  s_mul_i32 s10, s3, 176128
  s_lshl_b32 s15, s3, 12
  s_add_u32 m0, s15, 49152
  s_add_u32 s14, s10, 0
  buffer_load_dwordx4 v3, s[44:47], s14 offen  lds
  s_add_u32 m0, s15, 50176
  s_add_u32 s14, s10, 44032
  s_waitcnt vmcnt(1)
  buffer_load_dwordx4 v3, s[44:47], s14 offen  lds
  s_add_u32 m0, s15, 51200
  s_add_u32 s14, s10, 88064
  s_waitcnt vmcnt(1)
  buffer_load_dwordx4 v3, s[44:47], s14 offen  lds
  s_add_u32 m0, s15, 52224
  s_add_u32 s14, s10, 132096
  s_waitcnt vmcnt(1)
  buffer_load_dwordx4 v3, s[44:47], s14 offen  lds
  s_cmp_lt_u32 s3, 4
  s_cbranch_scc1 L_ph1_dn
  s_mov_b32 s44, s28
  s_mov_b32 s45, s29
  s_mov_b32 s46, 0x158000
  s_mov_b32 s47, 0x20000
  s_sub_u32 s11, s3, 4
  s_mul_i32 s10, s11, 352256
  s_lshl_b32 s15, s11, 13
  s_add_u32 m0, s15, 16384
  s_add_u32 s14, s10, 0
  s_waitcnt vmcnt(1)
  buffer_load_dwordx4 v3, s[44:47], s14 offen  lds
  s_add_u32 m0, s15, 17408
  s_add_u32 s14, s10, 44032
  s_waitcnt vmcnt(1)
  buffer_load_dwordx4 v3, s[44:47], s14 offen  lds
  s_add_u32 m0, s15, 18432
  s_add_u32 s14, s10, 88064
  s_waitcnt vmcnt(1)
  buffer_load_dwordx4 v3, s[44:47], s14 offen  lds
  s_add_u32 m0, s15, 19456
  s_add_u32 s14, s10, 132096
  s_waitcnt vmcnt(1)
  buffer_load_dwordx4 v3, s[44:47], s14 offen  lds
  s_add_u32 m0, s15, 20480
  s_add_u32 s14, s10, 176128
  s_waitcnt vmcnt(1)
  buffer_load_dwordx4 v3, s[44:47], s14 offen  lds
  s_add_u32 m0, s15, 21504
  s_add_u32 s14, s10, 220160
  s_waitcnt vmcnt(1)
  buffer_load_dwordx4 v3, s[44:47], s14 offen  lds
  s_add_u32 m0, s15, 22528
  s_add_u32 s14, s10, 264192
  s_waitcnt vmcnt(1)
  buffer_load_dwordx4 v3, s[44:47], s14 offen  lds
  s_add_u32 m0, s15, 23552
  s_add_u32 s14, s10, 308224
  s_waitcnt vmcnt(1)
  buffer_load_dwordx4 v3, s[44:47], s14 offen  lds
  s_branch L_ph1_bar
L_ph1_dn:
  s_lshl_b32 s10, s62, 15
  s_lshl_b32 s11, s3, 8
  s_add_u32 s10, s10, s11
  v_lshlrev_b32 v3, 13, v2
  v_lshl_add_u32 v3, v1, 4, v3
  v_add_u32 v3, s10, v3
  s_mov_b32 s14, 0
  s_waitcnt vmcnt(1)
  buffer_load_dwordx4 v[192:195], v3, s[52:55], s14 offen nt
  s_waitcnt vmcnt(1)
  buffer_load_dwordx4 v[196:199], v3, s[52:55], s14 offen offset:1024 nt
  s_waitcnt vmcnt(1)
  buffer_load_dwordx4 v[200:203], v3, s[52:55], s14 offen offset:2048 nt
  s_waitcnt vmcnt(1)
  buffer_load_dwordx4 v[204:207], v3, s[52:55], s14 offen offset:3072 nt
  s_mov_b32 s14, 4096
  s_waitcnt vmcnt(1)
  buffer_load_dwordx4 v[208:211], v3, s[52:55], s14 offen nt
  s_waitcnt vmcnt(1)
  buffer_load_dwordx4 v[212:215], v3, s[52:55], s14 offen offset:1024 nt
  s_waitcnt vmcnt(1)
  buffer_load_dwordx4 v[216:219], v3, s[52:55], s14 offen offset:2048 nt
  s_waitcnt vmcnt(1)
  buffer_load_dwordx4 v[220:223], v3, s[52:55], s14 offen offset:3072 nt
  s_waitcnt vmcnt(0)
  v_perm_b32 v160, v196, v192, s64
  v_perm_b32 v161, v204, v200, s64
  v_perm_b32 v162, v212, v208, s64
  v_perm_b32 v163, v220, v216, s64
  v_perm_b32 v164, v196, v192, s65
  v_perm_b32 v165, v204, v200, s65
  v_perm_b32 v166, v212, v208, s65
  v_perm_b32 v167, v220, v216, s65
  v_perm_b32 v168, v197, v193, s64
  v_perm_b32 v169, v205, v201, s64
  v_perm_b32 v170, v213, v209, s64
  v_perm_b32 v171, v221, v217, s64
  v_perm_b32 v172, v197, v193, s65
  v_perm_b32 v173, v205, v201, s65
  v_perm_b32 v174, v213, v209, s65
  v_perm_b32 v175, v221, v217, s65
  v_perm_b32 v176, v198, v194, s64
  v_perm_b32 v177, v206, v202, s64
  v_perm_b32 v178, v214, v210, s64
  v_perm_b32 v179, v222, v218, s64
  v_perm_b32 v180, v198, v194, s65
  v_perm_b32 v181, v206, v202, s65
  v_perm_b32 v182, v214, v210, s65
  v_perm_b32 v183, v222, v218, s65
  v_perm_b32 v184, v199, v195, s64
  v_perm_b32 v185, v207, v203, s64
  v_perm_b32 v186, v215, v211, s64
  v_perm_b32 v187, v223, v219, s64
  v_perm_b32 v188, v199, v195, s65
  v_perm_b32 v189, v207, v203, s65
  v_perm_b32 v190, v215, v211, s65
  v_perm_b32 v191, v223, v219, s65
L_ph1_bar:
  s_waitcnt vmcnt(0)
  s_barrier
L_ph2:
  s_mov_b32 s44, s24
  s_mov_b32 s45, s25
  s_mov_b32 s46, 0x400000
  s_mov_b32 s47, 0x20000
  s_lshl_b32 s10, s12, 17
  s_and_b32 s11, s3, 1
  s_lshl_b32 s11, s11, 16
  s_add_u32 s10, s10, s11
  s_lshl_b32 s11, s5, 7
  s_add_u32 s10, s10, s11
  v_lshlrev_b32 v3, 13, v2
  v_lshl_add_u32 v3, v1, 3, v3
  v_add_u32 v3, s10, v3
  v_and_b32 v5, 1, v1
  v_lshlrev_b32 v5, 15, v5
  v_lshl_add_u32 v5, v2, 9, v5
  v_and_b32 v4, 14, v1
  v_add_u32 v5, v5, v4
  s_lshl_b32 s10, s3, 4
  s_add_u32 s10, s10, 16384
  v_add_u32 v5, s10, v5
  v_mov_b32 v16, 0x3f803f80
  v_mov_b32 v17, 0x3f803f80
  v_mov_b32 v18, 0x3f803f80
  v_mov_b32 v19, 0x3f803f80
  s_cmp_lt_u32 s3, 4
  s_cselect_b32 s11, s63, 0
  s_mov_b32 s14, 0
  buffer_load_dwordx2 v[192:193], v3, s[44:47], s14 offen nt
  s_cmp_eq_u32 s11, 0
  s_cbranch_scc1 L_nog_5
  ds_read_u16 v8, v5 offset:0
  ds_read_u16 v9, v5 offset:64
  ds_read_u16 v10, v5 offset:128
  ds_read_u16 v11, v5 offset:192
  ds_read_u16 v12, v5 offset:256
  ds_read_u16 v13, v5 offset:320
  ds_read_u16 v14, v5 offset:384
  ds_read_u16 v15, v5 offset:448
  s_waitcnt lgkmcnt(0)
  v_lshl_or_b32 v96, v9, 16, v8
  v_lshl_or_b32 v97, v11, 16, v10
  v_lshl_or_b32 v98, v13, 16, v12
  v_lshl_or_b32 v99, v15, 16, v14
  s_nop 1
  v_mfma_f32_16x16x32_bf16 v[48:51], v[96:99], v[16:19], 0
L_nog_5:
  buffer_load_dwordx2 v[194:195], v3, s[44:47], s14 offen offset:1024 nt
  s_cmp_eq_u32 s11, 0
  s_cbranch_scc1 L_nog_6
  ds_read_u16 v8, v5 offset:2048
  ds_read_u16 v9, v5 offset:2112
  ds_read_u16 v10, v5 offset:2176
  ds_read_u16 v11, v5 offset:2240
  ds_read_u16 v12, v5 offset:2304
  ds_read_u16 v13, v5 offset:2368
  ds_read_u16 v14, v5 offset:2432
  ds_read_u16 v15, v5 offset:2496
  s_waitcnt lgkmcnt(0)
  v_lshl_or_b32 v100, v9, 16, v8
  v_lshl_or_b32 v101, v11, 16, v10
  v_lshl_or_b32 v102, v13, 16, v12
  v_lshl_or_b32 v103, v15, 16, v14
  s_nop 1
  v_mfma_f32_16x16x32_bf16 v[48:51], v[100:103], v[16:19], v[48:51]
L_nog_6:
  s_waitcnt vmcnt(1)
  buffer_load_dwordx2 v[196:197], v3, s[44:47], s14 offen offset:2048 nt
  s_cmp_eq_u32 s11, 0
  s_cbranch_scc1 L_nog_7
  ds_read_u16 v8, v5 offset:4096
  ds_read_u16 v9, v5 offset:4160
  ds_read_u16 v10, v5 offset:4224
  ds_read_u16 v11, v5 offset:4288
  ds_read_u16 v12, v5 offset:4352
  ds_read_u16 v13, v5 offset:4416
  ds_read_u16 v14, v5 offset:4480
  ds_read_u16 v15, v5 offset:4544
  s_waitcnt lgkmcnt(0)
  v_lshl_or_b32 v104, v9, 16, v8
  v_lshl_or_b32 v105, v11, 16, v10
  v_lshl_or_b32 v106, v13, 16, v12
  v_lshl_or_b32 v107, v15, 16, v14
  s_nop 1
  v_mfma_f32_16x16x32_bf16 v[48:51], v[104:107], v[16:19], v[48:51]
L_nog_7:
  s_waitcnt vmcnt(1)
  buffer_load_dwordx2 v[198:199], v3, s[44:47], s14 offen offset:3072 nt
  s_cmp_eq_u32 s11, 0
  s_cbranch_scc1 L_nog_8
  ds_read_u16 v8, v5 offset:6144
  ds_read_u16 v9, v5 offset:6208
  ds_read_u16 v10, v5 offset:6272
  ds_read_u16 v11, v5 offset:6336
  ds_read_u16 v12, v5 offset:6400
  ds_read_u16 v13, v5 offset:6464
  ds_read_u16 v14, v5 offset:6528
  ds_read_u16 v15, v5 offset:6592
  s_waitcnt lgkmcnt(0)
  v_lshl_or_b32 v108, v9, 16, v8
  v_lshl_or_b32 v109, v11, 16, v10
  v_lshl_or_b32 v110, v13, 16, v12
  v_lshl_or_b32 v111, v15, 16, v14
  s_nop 1
  v_mfma_f32_16x16x32_bf16 v[48:51], v[108:111], v[16:19], v[48:51]
L_nog_8:
  s_mov_b32 s14, 4096
  s_waitcnt vmcnt(1)
  buffer_load_dwordx2 v[200:201], v3, s[44:47], s14 offen nt
  s_cmp_eq_u32 s11, 0
  s_cbranch_scc1 L_nog_9
  ds_read_u16 v8, v5 offset:8192
  ds_read_u16 v9, v5 offset:8256
  ds_read_u16 v10, v5 offset:8320
  ds_read_u16 v11, v5 offset:8384
  ds_read_u16 v12, v5 offset:8448
  ds_read_u16 v13, v5 offset:8512
  ds_read_u16 v14, v5 offset:8576
  ds_read_u16 v15, v5 offset:8640
  s_waitcnt lgkmcnt(0)
  v_lshl_or_b32 v112, v9, 16, v8
  v_lshl_or_b32 v113, v11, 16, v10
  v_lshl_or_b32 v114, v13, 16, v12
  v_lshl_or_b32 v115, v15, 16, v14
  s_nop 1
  v_mfma_f32_16x16x32_bf16 v[48:51], v[112:115], v[16:19], v[48:51]
L_nog_9:
  s_waitcnt vmcnt(1)
  buffer_load_dwordx2 v[202:203], v3, s[44:47], s14 offen offset:1024 nt
  s_cmp_eq_u32 s11, 0
  s_cbranch_scc1 L_nog_10
  ds_read_u16 v8, v5 offset:10240
  ds_read_u16 v9, v5 offset:10304
  ds_read_u16 v10, v5 offset:10368
  ds_read_u16 v11, v5 offset:10432
  ds_read_u16 v12, v5 offset:10496
  ds_read_u16 v13, v5 offset:10560
  ds_read_u16 v14, v5 offset:10624
  ds_read_u16 v15, v5 offset:10688
  s_waitcnt lgkmcnt(0)
  v_lshl_or_b32 v116, v9, 16, v8
  v_lshl_or_b32 v117, v11, 16, v10
  v_lshl_or_b32 v118, v13, 16, v12
  v_lshl_or_b32 v119, v15, 16, v14
  s_nop 1
  v_mfma_f32_16x16x32_bf16 v[48:51], v[116:119], v[16:19], v[48:51]
L_nog_10:
  s_waitcnt vmcnt(1)
  buffer_load_dwordx2 v[204:205], v3, s[44:47], s14 offen offset:2048 nt
  s_cmp_eq_u32 s11, 0
  s_cbranch_scc1 L_nog_11
  ds_read_u16 v8, v5 offset:12288
  ds_read_u16 v9, v5 offset:12352
  ds_read_u16 v10, v5 offset:12416
  ds_read_u16 v11, v5 offset:12480
  ds_read_u16 v12, v5 offset:12544
  ds_read_u16 v13, v5 offset:12608
  ds_read_u16 v14, v5 offset:12672
  ds_read_u16 v15, v5 offset:12736
  s_waitcnt lgkmcnt(0)
  v_lshl_or_b32 v120, v9, 16, v8
  v_lshl_or_b32 v121, v11, 16, v10
  v_lshl_or_b32 v122, v13, 16, v12
  v_lshl_or_b32 v123, v15, 16, v14
  s_nop 1
  v_mfma_f32_16x16x32_bf16 v[48:51], v[120:123], v[16:19], v[48:51]
L_nog_11:
  s_waitcnt vmcnt(1)
  buffer_load_dwordx2 v[206:207], v3, s[44:47], s14 offen offset:3072 nt
  s_cmp_eq_u32 s11, 0
  s_cbranch_scc1 L_nog_12
  ds_read_u16 v8, v5 offset:14336
  ds_read_u16 v9, v5 offset:14400
  ds_read_u16 v10, v5 offset:14464
  ds_read_u16 v11, v5 offset:14528
  ds_read_u16 v12, v5 offset:14592
  ds_read_u16 v13, v5 offset:14656
  ds_read_u16 v14, v5 offset:14720
  ds_read_u16 v15, v5 offset:14784
  s_waitcnt lgkmcnt(0)
  v_lshl_or_b32 v124, v9, 16, v8
  v_lshl_or_b32 v125, v11, 16, v10
  v_lshl_or_b32 v126, v13, 16, v12
  v_lshl_or_b32 v127, v15, 16, v14
  s_nop 1
  v_mfma_f32_16x16x32_bf16 v[48:51], v[124:127], v[16:19], v[48:51]
L_nog_12:
  s_mov_b32 s14, 32768
  s_waitcnt vmcnt(1)
  buffer_load_dwordx2 v[208:209], v3, s[44:47], s14 offen nt
  s_cmp_eq_u32 s11, 0
  s_cbranch_scc1 L_nog_13
  ds_read_u16 v8, v5 offset:16384
  ds_read_u16 v9, v5 offset:16448
  ds_read_u16 v10, v5 offset:16512
  ds_read_u16 v11, v5 offset:16576
  ds_read_u16 v12, v5 offset:16640
  ds_read_u16 v13, v5 offset:16704
  ds_read_u16 v14, v5 offset:16768
  ds_read_u16 v15, v5 offset:16832
  s_waitcnt lgkmcnt(0)
  v_lshl_or_b32 v128, v9, 16, v8
  v_lshl_or_b32 v129, v11, 16, v10
  v_lshl_or_b32 v130, v13, 16, v12
  v_lshl_or_b32 v131, v15, 16, v14
  s_nop 1
  v_mfma_f32_16x16x32_bf16 v[48:51], v[128:131], v[16:19], v[48:51]
L_nog_13:
  s_waitcnt vmcnt(1)
  buffer_load_dwordx2 v[210:211], v3, s[44:47], s14 offen offset:1024 nt
  s_cmp_eq_u32 s11, 0
  s_cbranch_scc1 L_nog_14
  ds_read_u16 v8, v5 offset:18432
  ds_read_u16 v9, v5 offset:18496
  ds_read_u16 v10, v5 offset:18560
  ds_read_u16 v11, v5 offset:18624
  ds_read_u16 v12, v5 offset:18688
  ds_read_u16 v13, v5 offset:18752
  ds_read_u16 v14, v5 offset:18816
  ds_read_u16 v15, v5 offset:18880
  s_waitcnt lgkmcnt(0)
  v_lshl_or_b32 v132, v9, 16, v8
  v_lshl_or_b32 v133, v11, 16, v10
  v_lshl_or_b32 v134, v13, 16, v12
  v_lshl_or_b32 v135, v15, 16, v14
  s_nop 1
  v_mfma_f32_16x16x32_bf16 v[48:51], v[132:135], v[16:19], v[48:51]
L_nog_14:
  s_waitcnt vmcnt(1)
  buffer_load_dwordx2 v[212:213], v3, s[44:47], s14 offen offset:2048 nt
  s_cmp_eq_u32 s11, 0
  s_cbranch_scc1 L_nog_15
  ds_read_u16 v8, v5 offset:20480
  ds_read_u16 v9, v5 offset:20544
  ds_read_u16 v10, v5 offset:20608
  ds_read_u16 v11, v5 offset:20672
  ds_read_u16 v12, v5 offset:20736
  ds_read_u16 v13, v5 offset:20800
  ds_read_u16 v14, v5 offset:20864
  ds_read_u16 v15, v5 offset:20928
  s_waitcnt lgkmcnt(0)
  v_lshl_or_b32 v136, v9, 16, v8
  v_lshl_or_b32 v137, v11, 16, v10
  v_lshl_or_b32 v138, v13, 16, v12
  v_lshl_or_b32 v139, v15, 16, v14
  s_nop 1
  v_mfma_f32_16x16x32_bf16 v[48:51], v[136:139], v[16:19], v[48:51]
L_nog_15:
  s_waitcnt vmcnt(1)
  buffer_load_dwordx2 v[214:215], v3, s[44:47], s14 offen offset:3072 nt
  s_cmp_eq_u32 s11, 0
  s_cbranch_scc1 L_nog_16
  ds_read_u16 v8, v5 offset:22528
  ds_read_u16 v9, v5 offset:22592
  ds_read_u16 v10, v5 offset:22656
  ds_read_u16 v11, v5 offset:22720
  ds_read_u16 v12, v5 offset:22784
  ds_read_u16 v13, v5 offset:22848
  ds_read_u16 v14, v5 offset:22912
  ds_read_u16 v15, v5 offset:22976
  s_waitcnt lgkmcnt(0)
  v_lshl_or_b32 v140, v9, 16, v8
  v_lshl_or_b32 v141, v11, 16, v10
  v_lshl_or_b32 v142, v13, 16, v12
  v_lshl_or_b32 v143, v15, 16, v14
  s_nop 1
  v_mfma_f32_16x16x32_bf16 v[48:51], v[140:143], v[16:19], v[48:51]
L_nog_16:
  s_mov_b32 s14, 36864
  s_waitcnt vmcnt(1)
  buffer_load_dwordx2 v[216:217], v3, s[44:47], s14 offen nt
  s_cmp_eq_u32 s11, 0
  s_cbranch_scc1 L_nog_17
  ds_read_u16 v8, v5 offset:24576
  ds_read_u16 v9, v5 offset:24640
  ds_read_u16 v10, v5 offset:24704
  ds_read_u16 v11, v5 offset:24768
  ds_read_u16 v12, v5 offset:24832
  ds_read_u16 v13, v5 offset:24896
  ds_read_u16 v14, v5 offset:24960
  ds_read_u16 v15, v5 offset:25024
  s_waitcnt lgkmcnt(0)
  v_lshl_or_b32 v144, v9, 16, v8
  v_lshl_or_b32 v145, v11, 16, v10
  v_lshl_or_b32 v146, v13, 16, v12
  v_lshl_or_b32 v147, v15, 16, v14
  s_nop 1
  v_mfma_f32_16x16x32_bf16 v[48:51], v[144:147], v[16:19], v[48:51]
L_nog_17:
  s_waitcnt vmcnt(1)
  buffer_load_dwordx2 v[218:219], v3, s[44:47], s14 offen offset:1024 nt
  s_cmp_eq_u32 s11, 0
  s_cbranch_scc1 L_nog_18
  ds_read_u16 v8, v5 offset:26624
  ds_read_u16 v9, v5 offset:26688
  ds_read_u16 v10, v5 offset:26752
  ds_read_u16 v11, v5 offset:26816
  ds_read_u16 v12, v5 offset:26880
  ds_read_u16 v13, v5 offset:26944
  ds_read_u16 v14, v5 offset:27008
  ds_read_u16 v15, v5 offset:27072
  s_waitcnt lgkmcnt(0)
  v_lshl_or_b32 v148, v9, 16, v8
  v_lshl_or_b32 v149, v11, 16, v10
  v_lshl_or_b32 v150, v13, 16, v12
  v_lshl_or_b32 v151, v15, 16, v14
  s_nop 1
  v_mfma_f32_16x16x32_bf16 v[48:51], v[148:151], v[16:19], v[48:51]
L_nog_18:
  s_waitcnt vmcnt(1)
  buffer_load_dwordx2 v[220:221], v3, s[44:47], s14 offen offset:2048 nt
  s_cmp_eq_u32 s11, 0
  s_cbranch_scc1 L_nog_19
  ds_read_u16 v8, v5 offset:28672
  ds_read_u16 v9, v5 offset:28736
  ds_read_u16 v10, v5 offset:28800
  ds_read_u16 v11, v5 offset:28864
  ds_read_u16 v12, v5 offset:28928
  ds_read_u16 v13, v5 offset:28992
  ds_read_u16 v14, v5 offset:29056
  ds_read_u16 v15, v5 offset:29120
  s_waitcnt lgkmcnt(0)
  v_lshl_or_b32 v152, v9, 16, v8
  v_lshl_or_b32 v153, v11, 16, v10
  v_lshl_or_b32 v154, v13, 16, v12
  v_lshl_or_b32 v155, v15, 16, v14
  s_nop 1
  v_mfma_f32_16x16x32_bf16 v[48:51], v[152:155], v[16:19], v[48:51]
L_nog_19:
  s_waitcnt vmcnt(1)
  buffer_load_dwordx2 v[222:223], v3, s[44:47], s14 offen offset:3072 nt
  s_cmp_eq_u32 s11, 0
  s_cbranch_scc1 L_nog_20
  ds_read_u16 v8, v5 offset:30720
  ds_read_u16 v9, v5 offset:30784
  ds_read_u16 v10, v5 offset:30848
  ds_read_u16 v11, v5 offset:30912
  ds_read_u16 v12, v5 offset:30976
  ds_read_u16 v13, v5 offset:31040
  ds_read_u16 v14, v5 offset:31104
  ds_read_u16 v15, v5 offset:31168
  s_waitcnt lgkmcnt(0)
  v_lshl_or_b32 v156, v9, 16, v8
  v_lshl_or_b32 v157, v11, 16, v10
  v_lshl_or_b32 v158, v13, 16, v12
  v_lshl_or_b32 v159, v15, 16, v14
  s_nop 1
  v_mfma_f32_16x16x32_bf16 v[48:51], v[156:159], v[16:19], v[48:51]
L_nog_20:
  s_waitcnt vmcnt(0)
  v_perm_b32 v64, v194, v192, s64
  v_perm_b32 v65, v198, v196, s64
  v_perm_b32 v66, v202, v200, s64
  v_perm_b32 v67, v206, v204, s64
  v_perm_b32 v68, v194, v192, s65
  v_perm_b32 v69, v198, v196, s65
  v_perm_b32 v70, v202, v200, s65
  v_perm_b32 v71, v206, v204, s65
  v_perm_b32 v72, v195, v193, s64
  v_perm_b32 v73, v199, v197, s64
  v_perm_b32 v74, v203, v201, s64
  v_perm_b32 v75, v207, v205, s64
  v_perm_b32 v76, v195, v193, s65
  v_perm_b32 v77, v199, v197, s65
  v_perm_b32 v78, v203, v201, s65
  v_perm_b32 v79, v207, v205, s65
  v_perm_b32 v80, v210, v208, s64
  v_perm_b32 v81, v214, v212, s64
  v_perm_b32 v82, v218, v216, s64
  v_perm_b32 v83, v222, v220, s64
  v_perm_b32 v84, v210, v208, s65
  v_perm_b32 v85, v214, v212, s65
  v_perm_b32 v86, v218, v216, s65
  v_perm_b32 v87, v222, v220, s65
  v_perm_b32 v88, v211, v209, s64
  v_perm_b32 v89, v215, v213, s64
  v_perm_b32 v90, v219, v217, s64
  v_perm_b32 v91, v223, v221, s64
  v_perm_b32 v92, v211, v209, s65
  v_perm_b32 v93, v215, v213, s65
  v_perm_b32 v94, v219, v217, s65
  v_perm_b32 v95, v223, v221, s65
  v_mov_b32 v3, 0xb000
  s_mov_b32 s70, 0
L_ptag_21:
  buffer_load_dwordx4 v[4:7], v3, s[48:51], 0 offen sc1
  s_add_u32 s70, s70, 1
  s_waitcnt vmcnt(0)
  v_cmp_ne_u64 vcc, s[36:37], v[6:7]
  s_cbranch_vccz L_ptagd_22
  s_sleep 16
  s_cmp_lt_u32 s70, 40000
  s_cbranch_scc1 L_ptag_21
L_ptagd_22:
  s_mov_b64 exec, -1
  v_and_b32 v4, 0x2000, v4
  v_xor_b32 v47, v47, v4
  v_add_u32 v5, v5, v30
  v_lshlrev_b32 v5, 11, v5
  v_and_b32 v5, 0x2000, v5
  v_xor_b32 v5, v5, v4
  v_or_b32 v54, v54, v5
  buffer_load_dwordx4 v[216:219], v47, s[48:51], 0 offen offset:0 sc1
  buffer_load_dwordx4 v[220:223], v47, s[48:51], s22 offen offset:0 sc1
  buffer_load_dwordx4 v[224:227], v47, s[48:51], 0 offen offset:256 sc1
  buffer_load_dwordx4 v[228:231], v47, s[48:51], s22 offen offset:256 sc1
  s_cmp_eq_u32 s3, 6
  s_cbranch_scc0 L_touch_done
  buffer_load_dwordx4 v[216:219], v54, s[48:51], 0 offen offset:0 sc1
  buffer_load_dwordx4 v[216:219], v54, s[48:51], 0 offen offset:1024 sc1
  buffer_load_dwordx4 v[216:219], v54, s[48:51], 0 offen offset:2048 sc1
  buffer_load_dwordx4 v[216:219], v54, s[48:51], 0 offen offset:3072 sc1
  buffer_load_dwordx4 v[216:219], v54, s[48:51], s22 offen offset:0 sc1
  buffer_load_dwordx4 v[216:219], v54, s[48:51], s22 offen offset:1024 sc1
L_touch_done:
  v_mov_b32 v192, 0
  v_mov_b32 v193, 0
  v_mov_b32 v194, 0
  v_mov_b32 v195, 0
  v_mov_b32 v196, 0
  v_mov_b32 v197, 0
  v_mov_b32 v198, 0
  v_mov_b32 v199, 0
  v_mov_b32 v200, 0
  v_mov_b32 v201, 0
  v_mov_b32 v202, 0
  v_mov_b32 v203, 0
  v_mov_b32 v204, 0
  v_mov_b32 v205, 0
  v_mov_b32 v206, 0
  v_mov_b32 v207, 0
  v_mov_b32 v208, 0xff800000
  v_mov_b32 v209, 0
  s_waitcnt vmcnt(0)
  s_barrier
L_tail:
  s_mov_b64 exec, s[16:17]
  s_mov_b32 s70, 0
  s_mov_b32 s15, 0
L_ptag_23:
  buffer_load_dwordx4 v[208:211], v59, s[48:51], s15 offen offset:512 sc1
  s_add_u32 s70, s70, 1
  s_and_b32 s71, s70, 1
  s_cselect_b32 s15, 0, 0x40000
  s_waitcnt vmcnt(0)
  v_cmp_ne_u64 vcc, s[36:37], v[210:211]
  s_cbranch_vccz L_ptagd_24
  s_mov_b64 exec, vcc
  s_sleep 16
  s_cmp_lt_u32 s70, 40000
  s_cbranch_scc1 L_ptag_23
L_ptagd_24:
  s_mov_b64 exec, -1
  v_max_f32_dpp v20, v208, v208 quad_perm:[1,0,3,2] row_mask:0xf bank_mask:0xf
  s_nop 1
  v_max_f32_dpp v20, v20, v20 quad_perm:[2,3,0,1] row_mask:0xf bank_mask:0xf
  v_sub_f32 v20, v208, v20
  v_mul_f32 v20, 0x3fb8aa3b, v20
  v_exp_f32 v20, v20
  s_nop 0
  v_mul_f32 v21, v209, v20
  s_nop 1
  v_add_f32_dpp v21, v21, v21 quad_perm:[1,0,3,2] row_mask:0xf bank_mask:0xf
  s_nop 1
  v_add_f32_dpp v21, v21, v21 quad_perm:[2,3,0,1] row_mask:0xf bank_mask:0xf
  v_rcp_f32 v21, v21
  s_nop 0
  v_mul_f32 v20, v20, v21
  s_mov_b64 exec, s[16:17]
  s_mov_b32 s70, 0
  s_mov_b32 s15, 0
L_ptag_25:
  buffer_load_dwordx4 v[192:195], v60, s[48:51], s15 offen offset:0 sc1
  buffer_load_dwordx4 v[196:199], v60, s[48:51], s15 offen offset:16 sc1
  buffer_load_dwordx4 v[200:203], v60, s[48:51], s15 offen offset:128 sc1
  buffer_load_dwordx4 v[204:207], v60, s[48:51], s15 offen offset:144 sc1
  s_add_u32 s70, s70, 1
  s_and_b32 s71, s70, 7
  s_cselect_b32 s15, 0, 0x40000
  s_waitcnt vmcnt(3)
  v_cmp_ne_u64 vcc, s[36:37], v[192:193]
  s_waitcnt vmcnt(2)
  v_cmp_ne_u64 s[68:69], s[36:37], v[198:199]
  s_waitcnt vmcnt(1)
  v_cmp_ne_u64 s[66:67], s[36:37], v[200:201]
  s_or_b64 vcc, vcc, s[68:69]
  s_waitcnt vmcnt(0)
  v_cmp_ne_u64 s[68:69], s[36:37], v[206:207]
  s_or_b64 vcc, vcc, s[66:67]
  s_or_b64 vcc, vcc, s[68:69]
  s_cbranch_scc0 L_ptagd_26
  s_mov_b64 exec, vcc
  s_sleep 1
  s_cmp_lt_u32 s70, 40000
  s_cbranch_scc1 L_ptag_25
L_ptagd_26:
  s_mov_b64 exec, -1
  v_mfma_f32_16x16x32_bf16 v[4:7], v[194:197], v[64:67], 0
  v_mfma_f32_16x16x32_bf16 v[4:7], v[202:205], v[80:83], v[4:7]
  v_mfma_f32_16x16x32_bf16 v[8:11], v[194:197], v[68:71], 0
  v_mfma_f32_16x16x32_bf16 v[8:11], v[202:205], v[84:87], v[8:11]
  v_mfma_f32_16x16x32_bf16 v[12:15], v[194:197], v[72:75], 0
  v_mfma_f32_16x16x32_bf16 v[12:15], v[202:205], v[88:91], v[12:15]
  v_mfma_f32_16x16x32_bf16 v[16:19], v[194:197], v[76:79], 0
  v_mfma_f32_16x16x32_bf16 v[16:19], v[202:205], v[92:95], v[16:19]
  s_nop 1
  v_mul_f32_dpp v212, v20, v4 row_newbcast:0 row_mask:0xf bank_mask:0xf
  v_fmac_f32_dpp v212, v20, v5 row_newbcast:1 row_mask:0xf bank_mask:0xf
  v_fmac_f32_dpp v212, v20, v6 row_newbcast:2 row_mask:0xf bank_mask:0xf
  v_mul_f32_dpp v213, v20, v8 row_newbcast:0 row_mask:0xf bank_mask:0xf
  v_fmac_f32_dpp v213, v20, v9 row_newbcast:1 row_mask:0xf bank_mask:0xf
  v_fmac_f32_dpp v213, v20, v10 row_newbcast:2 row_mask:0xf bank_mask:0xf
  v_mul_f32_dpp v214, v20, v12 row_newbcast:0 row_mask:0xf bank_mask:0xf
  v_fmac_f32_dpp v214, v20, v13 row_newbcast:1 row_mask:0xf bank_mask:0xf
  v_fmac_f32_dpp v214, v20, v14 row_newbcast:2 row_mask:0xf bank_mask:0xf
  v_mul_f32_dpp v215, v20, v16 row_newbcast:0 row_mask:0xf bank_mask:0xf
  v_fmac_f32_dpp v215, v20, v17 row_newbcast:1 row_mask:0xf bank_mask:0xf
  v_fmac_f32_dpp v215, v20, v18 row_newbcast:2 row_mask:0xf bank_mask:0xf
  s_mov_b32 exec_hi, 0
  ds_write_b128 v56, v[212:215] offset:8192
  s_mov_b64 exec, -1
  s_waitcnt lgkmcnt(0)
  s_barrier
  s_cmp_eq_u32 s3, 2
  s_cbranch_scc0 L_own_done
  ds_read2st64_b64 v[4:7], v57 offset0:16 offset1:17
  ds_read2st64_b64 v[8:11], v57 offset0:18 offset1:19
  ds_read2st64_b64 v[12:15], v57 offset0:20 offset1:21
  ds_read2st64_b64 v[16:19], v57 offset0:22 offset1:23
  s_waitcnt lgkmcnt(2)
  v_pk_add_f32 v[4:5], v[4:5], v[6:7]
  v_pk_add_f32 v[8:9], v[8:9], v[10:11]
  s_waitcnt lgkmcnt(1)
  v_pk_add_f32 v[12:13], v[12:13], v[14:15]
  v_pk_add_f32 v[4:5], v[4:5], v[8:9]
  s_waitcnt lgkmcnt(0)
  v_pk_add_f32 v[16:17], v[16:17], v[18:19]
  v_pk_add_f32 v[4:5], v[4:5], v[12:13]
  v_pk_add_f32 v[4:5], v[4:5], v[16:17]
  v_cvt_pk_bf16_f32 v4, v4, v5
  s_bitcmp1_b32 s4, 0
  s_nop 0
  v_mov_b32_dpp v42, v4 quad_perm:[0,0,2,2] row_mask:0xf bank_mask:0xf
  v_mov_b32_dpp v43, v4 quad_perm:[1,1,3,3] row_mask:0xf bank_mask:0xf
  s_cbranch_scc1 L_y_odd
  buffer_store_dwordx4 v[40:43], v58, s[48:51], 0 offen sc1
  s_branch L_y_st
L_y_odd:
  buffer_store_dwordx4 v[42:45], v58, s[48:51], 0 offen sc1
L_y_st:
L_own_done:
  s_barrier
  s_mov_b32 s70, 0
L_ptag_27:
  buffer_load_dwordx4 v[216:219], v47, s[48:51], 0 offen offset:0 sc1
  buffer_load_dwordx4 v[220:223], v47, s[48:51], s22 offen offset:0 sc1
  buffer_load_dwordx4 v[224:227], v47, s[48:51], 0 offen offset:256 sc1
  buffer_load_dwordx4 v[228:231], v47, s[48:51], s22 offen offset:256 sc1
  s_add_u32 s70, s70, 1
  s_waitcnt vmcnt(3)
  s_mov_b64 exec, -1
  v_cmp_ne_u64 vcc, s[36:37], v[216:217]
  s_waitcnt vmcnt(2)
  v_mfma_f32_16x16x32_bf16 v[4:7], v[232:235], v[218:221], 0
  v_cmp_ne_u64 s[68:69], s[36:37], v[222:223]
  s_waitcnt vmcnt(1)
  v_cmp_ne_u64 s[66:67], s[36:37], v[224:225]
  s_or_b64 vcc, vcc, s[68:69]
  s_waitcnt vmcnt(0)
  v_mfma_f32_16x16x32_bf16 v[4:7], v[236:239], v[226:229], v[4:7]
  v_cmp_ne_u64 s[68:69], s[36:37], v[230:231]
  s_or_b64 vcc, vcc, s[66:67]
  s_or_b64 vcc, vcc, s[68:69]
  s_cbranch_scc0 L_ptagd_28
  s_mov_b64 exec, vcc
  s_cmp_lt_u32 s70, 40000
  s_cbranch_scc1 L_ptag_27
L_ptagd_28:
  s_mov_b64 exec, -1
  s_nop 3
  v_cvt_pk_bf16_f32 v8, v4, v5
  v_cvt_pk_bf16_f32 v9, v6, v7
  v_lshlrev_b32 v4, 16, v8
  v_and_b32 v5, 0xffff0000, v8
  v_lshlrev_b32 v6, 16, v9
  v_and_b32 v7, 0xffff0000, v9
  v_pk_add_f32 v[4:5], v[4:5], v[248:249]
  v_pk_add_f32 v[6:7], v[6:7], v[250:251]
  v_cvt_pk_bf16_f32 v4, v4, v5
  v_cvt_pk_bf16_f32 v5, v6, v7
  s_mov_b32 exec_hi, 0
  ds_write_b64 v55, v[4:5] offset:2560
  s_mov_b64 exec, -1
  s_waitcnt lgkmcnt(0)
  s_barrier
  s_cmp_eq_u32 s63, 0
  s_cbranch_scc1 L_notffn
  s_cmp_lt_u32 s3, 4
  s_cbranch_scc0 L_stats
  ds_read_b128 v[192:195], v52 offset:2560
  ds_read_b128 v[196:199], v52 offset:2624
  ds_read_b128 v[200:203], v52 offset:2688
  ds_read_b128 v[204:207], v52 offset:2752
  ds_read_b128 v[208:211], v52 offset:2816
  ds_read_b128 v[212:215], v52 offset:2880
  ds_read_b128 v[216:219], v52 offset:2944
  ds_read_b128 v[220:223], v52 offset:3008
  ds_read_b128 v[224:227], v52 offset:3072
  ds_read_b128 v[228:231], v52 offset:3136
  v_dot2_f32_bf16 v16, v4, v62, 0
  v_dot2_f32_bf16 v17, v4, v4, 0
  v_dot2_f32_bf16 v16, v5, v62, v16
  v_dot2_f32_bf16 v17, v5, v5, v17
  s_nop 1
  v_add_f32_dpp v16, v16, v16 row_ror:8 row_mask:0xf bank_mask:0xf
  v_add_f32_dpp v17, v17, v17 row_ror:8 row_mask:0xf bank_mask:0xf
  s_nop 0
  v_add_f32_dpp v16, v16, v16 row_ror:4 row_mask:0xf bank_mask:0xf
  v_add_f32_dpp v17, v17, v17 row_ror:4 row_mask:0xf bank_mask:0xf
  s_nop 0
  v_add_f32_dpp v16, v16, v16 row_ror:2 row_mask:0xf bank_mask:0xf
  v_add_f32_dpp v17, v17, v17 row_ror:2 row_mask:0xf bank_mask:0xf
  s_nop 0
  v_add_f32_dpp v16, v16, v16 row_ror:1 row_mask:0xf bank_mask:0xf
  v_add_f32_dpp v17, v17, v17 row_ror:1 row_mask:0xf bank_mask:0xf
  s_mov_b64 exec, 0x10001
  ds_write_b64 v63, v[16:17] offset:384
  s_mov_b64 exec, -1
  s_waitcnt lgkmcnt(8)
  v_mfma_f32_16x16x32_bf16 v[8:11], v[96:99], v[192:195], 0
  v_mfma_f32_16x16x32_bf16 v[8:11], v[100:103], v[196:199], v[8:11]
  v_mfma_f32_16x16x32_bf16 v[8:11], v[104:107], v[200:203], v[8:11]
  ds_read_b128 v[192:195], v52 offset:3200
  ds_read_b128 v[196:199], v52 offset:3264
  s_waitcnt lgkmcnt(2)
  v_mfma_f32_16x16x32_bf16 v[8:11], v[108:111], v[204:207], v[8:11]
  s_barrier
  ds_read_b64 v[4:5], v61 offset:384
  ds_read_b128 v[200:203], v52 offset:3328
  ds_read_b128 v[204:207], v52 offset:3392
  v_mfma_f32_16x16x32_bf16 v[8:11], v[112:115], v[208:211], v[8:11]
  v_mfma_f32_16x16x32_bf16 v[8:11], v[116:119], v[212:215], v[8:11]
  v_mfma_f32_16x16x32_bf16 v[8:11], v[120:123], v[216:219], v[8:11]
  ds_read_b128 v[208:211], v52 offset:3456
  ds_read_b128 v[212:215], v52 offset:3520
  v_mfma_f32_16x16x32_bf16 v[8:11], v[124:127], v[220:223], v[8:11]
  v_mov_b32 v14, s26
  s_waitcnt lgkmcnt(4)
  v_add_f32_dpp v4, v4, v4 quad_perm:[1,0,3,2] row_mask:0xf bank_mask:0xf
  v_add_f32_dpp v5, v5, v5 quad_perm:[1,0,3,2] row_mask:0xf bank_mask:0xf
  v_mfma_f32_16x16x32_bf16 v[8:11], v[128:131], v[224:227], v[8:11]
  v_add_f32_dpp v4, v4, v4 quad_perm:[2,3,0,1] row_mask:0xf bank_mask:0xf
  v_add_f32_dpp v5, v5, v5 quad_perm:[2,3,0,1] row_mask:0xf bank_mask:0xf
  v_mfma_f32_16x16x32_bf16 v[8:11], v[132:135], v[228:231], v[8:11]
  v_add_f32_dpp v4, v4, v4 row_half_mirror row_mask:0xf bank_mask:0xf
  v_add_f32_dpp v5, v5, v5 row_half_mirror row_mask:0xf bank_mask:0xf
  v_mfma_f32_16x16x32_bf16 v[8:11], v[136:139], v[192:195], v[8:11]
  v_mul_f32 v4, 0x3b000000, v4
  v_mul_f32 v5, 0x3b000000, v5
  v_mfma_f32_16x16x32_bf16 v[8:11], v[140:143], v[196:199], v[8:11]
  v_fma_f32 v5, -v4, v4, v5
  v_max_f32 v5, 0, v5
  s_waitcnt lgkmcnt(3)
  v_mfma_f32_16x16x32_bf16 v[8:11], v[144:147], v[200:203], v[8:11]
  v_cvt_pk_bf16_f32 v6, v4, v5
  v_and_b32 v5, 0xffff0000, v6
  s_waitcnt lgkmcnt(2)
  v_mfma_f32_16x16x32_bf16 v[8:11], v[148:151], v[204:207], v[8:11]
  v_lshlrev_b32 v4, 16, v6
  v_add_f32 v5, 0x3727c5ac, v5
  s_waitcnt lgkmcnt(1)
  v_mfma_f32_16x16x32_bf16 v[8:11], v[152:155], v[208:211], v[8:11]
  v_cvt_pk_bf16_f32 v5, v5, v5
  v_and_b32 v5, 0xffff0000, v5
  s_waitcnt lgkmcnt(0)
  v_mfma_f32_16x16x32_bf16 v[8:11], v[156:159], v[212:215], v[8:11]
  v_sqrt_f32 v5, v5
  s_nop 0
  v_cvt_pk_bf16_f32 v5, v5, v5
  v_and_b32 v5, 0xffff0000, v5
  v_rcp_f32 v5, v5
  s_nop 2
  v_fma_f32 v8, -v4, v48, v8
  v_fma_f32 v9, -v4, v49, v9
  v_fma_f32 v10, -v4, v50, v10
  v_fma_f32 v11, -v4, v51, v11
  v_mul_f32 v8, v8, v5
  v_mul_f32 v9, v9, v5
  v_mul_f32 v10, v10, v5
  v_mul_f32 v11, v11, v5
  v_cvt_pk_bf16_f32 v16, v8, v9
  v_cvt_pk_bf16_f32 v17, v10, v11
  v_lshlrev_b32 v8, 16, v16
  v_and_b32 v9, 0xffff0000, v16
  v_lshlrev_b32 v10, 16, v17
  v_and_b32 v11, 0xffff0000, v17
  v_mul_f32 v12, v8, v8
  v_mul_f32 v13, v10, v10
  v_fma_f32 v12, v12, s27, v14
  v_fma_f32 v13, v13, s27, v14
  v_mul_f32 v12, v12, v8
  v_mul_f32 v13, v13, v10
  v_exp_f32 v12, -v12
  v_exp_f32 v13, -v13
  v_add_f32 v12, 1.0, v12
  v_add_f32 v13, 1.0, v13
  v_rcp_f32 v12, v12
  v_rcp_f32 v13, v13
  v_mul_f32 v12, v12, v8
  v_mul_f32 v13, v13, v10
  v_cvt_pk_bf16_f32 v16, v12, v13
  v_lshlrev_b32 v12, 16, v16
  v_and_b32 v13, 0xffff0000, v16
  v_mul_f32 v12, v12, v9
  v_mul_f32 v13, v13, v11
  v_cvt_pk_bf16_f32 v12, v12, v13
  ds_write_b32 v53, v12 offset:4864
  s_waitcnt lgkmcnt(0)
  s_barrier
  ds_read_b128 v[192:195], v32
  ds_read_b128 v[196:199], v33
  ds_read_b128 v[200:203], v34
  ds_read_b128 v[204:207], v35
  ds_read_b128 v[208:211], v36
  ds_read_b128 v[212:215], v37
  ds_read_b128 v[216:219], v38
  ds_read_b128 v[220:223], v39
  s_waitcnt lgkmcnt(7)
  v_mfma_f32_16x16x32_bf16 v[8:11], v[160:163], v[192:195], 0
  s_waitcnt lgkmcnt(6)
  v_mfma_f32_16x16x32_bf16 v[8:11], v[164:167], v[196:199], v[8:11]
  s_waitcnt lgkmcnt(5)
  v_mfma_f32_16x16x32_bf16 v[8:11], v[168:171], v[200:203], v[8:11]
  s_waitcnt lgkmcnt(4)
  v_mfma_f32_16x16x32_bf16 v[8:11], v[172:175], v[204:207], v[8:11]
  s_waitcnt lgkmcnt(3)
  v_mfma_f32_16x16x32_bf16 v[8:11], v[176:179], v[208:211], v[8:11]
  s_waitcnt lgkmcnt(2)
  v_mfma_f32_16x16x32_bf16 v[8:11], v[180:183], v[212:215], v[8:11]
  s_waitcnt lgkmcnt(1)
  v_mfma_f32_16x16x32_bf16 v[8:11], v[184:187], v[216:219], v[8:11]
  s_waitcnt lgkmcnt(0)
  v_mfma_f32_16x16x32_bf16 v[8:11], v[188:191], v[220:223], v[8:11]
  s_bitcmp1_b32 s62, 3
  s_nop 6
  v_cvt_pk_bf16_f32 v26, v8, v9
  v_cvt_pk_bf16_f32 v27, v10, v11
  s_cbranch_scc1 L_z_odd
  buffer_store_dwordx4 v[24:27], v54, s[48:51], 0 offen sc1
  s_branch L_s_end
L_z_odd:
  buffer_store_dwordx4 v[26:29], v54, s[48:51], 0 offen sc1
  s_branch L_s_end
L_stats:
  v_dot2_f32_bf16 v16, v4, v62, 0
  v_dot2_f32_bf16 v17, v4, v4, 0
  v_dot2_f32_bf16 v16, v5, v62, v16
  v_dot2_f32_bf16 v17, v5, v5, v17
  s_nop 1
  v_add_f32_dpp v16, v16, v16 row_ror:8 row_mask:0xf bank_mask:0xf
  v_add_f32_dpp v17, v17, v17 row_ror:8 row_mask:0xf bank_mask:0xf
  s_nop 0
  v_add_f32_dpp v16, v16, v16 row_ror:4 row_mask:0xf bank_mask:0xf
  v_add_f32_dpp v17, v17, v17 row_ror:4 row_mask:0xf bank_mask:0xf
  s_nop 0
  v_add_f32_dpp v16, v16, v16 row_ror:2 row_mask:0xf bank_mask:0xf
  v_add_f32_dpp v17, v17, v17 row_ror:2 row_mask:0xf bank_mask:0xf
  s_nop 0
  v_add_f32_dpp v16, v16, v16 row_ror:1 row_mask:0xf bank_mask:0xf
  v_add_f32_dpp v17, v17, v17 row_ror:1 row_mask:0xf bank_mask:0xf
  s_mov_b64 exec, 0x10001
  ds_write_b64 v63, v[16:17] offset:384
  s_mov_b64 exec, -1
  s_waitcnt lgkmcnt(0)
  s_barrier
  s_barrier
L_notffn:
  s_cmp_eq_u32 s3, 6
  s_cbranch_scc0 L_epoch
  s_cmp_ge_u32 s2, 32
  s_cbranch_scc0 L_s_end
L_reducer:
  ds_read_u16 v46, v53 offset:2560
  v_mov_b32 v116, 0
  v_mov_b32 v117, 0
  v_mov_b32 v118, s36
  v_mov_b32 v119, s37
  s_waitcnt lgkmcnt(0)
  v_lshlrev_b32 v46, 16, v46
  s_mov_b32 s70, 0
L_ptag_29:
  buffer_load_dwordx4 v[96:99], v54, s[48:51], 0 offen offset:0 sc1
  buffer_load_dwordx4 v[100:103], v54, s[48:51], 0 offen offset:1024 sc1
  buffer_load_dwordx4 v[104:107], v54, s[48:51], 0 offen offset:2048 sc1
  buffer_load_dwordx4 v[108:111], v54, s[48:51], 0 offen offset:3072 sc1
  buffer_load_dwordx4 v[112:115], v54, s[48:51], s22 offen offset:0 sc1
  s_and_b64 exec, exec, s[20:21]
  buffer_load_dwordx4 v[116:119], v54, s[48:51], s22 offen offset:1024 sc1
  s_mov_b64 exec, -1
  s_add_u32 s70, s70, 1
  s_waitcnt vmcnt(5)
  v_cmp_ne_u64 vcc, s[36:37], v[96:97]
  s_waitcnt vmcnt(4)
  v_mfma_f32_16x16x32_bf16 v[8:11], v[144:147], v[98:101], 0
  v_cmp_ne_u64 s[68:69], s[36:37], v[102:103]
  s_waitcnt vmcnt(3)
  v_cmp_ne_u64 s[66:67], s[36:37], v[104:105]
  s_or_b64 vcc, vcc, s[68:69]
  s_waitcnt vmcnt(2)
  v_mfma_f32_16x16x32_bf16 v[8:11], v[144:147], v[106:109], v[8:11]
  v_cmp_ne_u64 s[68:69], s[36:37], v[110:111]
  s_or_b64 vcc, vcc, s[66:67]
  s_waitcnt vmcnt(1)
  v_cmp_ne_u64 s[66:67], s[36:37], v[112:113]
  s_or_b64 vcc, vcc, s[68:69]
  s_waitcnt vmcnt(0)
  v_mfma_f32_16x16x32_bf16 v[8:11], v[144:147], v[114:117], v[8:11]
  v_cmp_ne_u64 s[68:69], s[36:37], v[118:119]
  s_or_b64 vcc, vcc, s[66:67]
  s_or_b64 vcc, vcc, s[68:69]
  s_cbranch_scc0 L_ptagd_30
  s_cmp_lt_u32 s70, 40000
  s_cbranch_scc1 L_ptag_29
L_ptagd_30:
  s_mov_b64 exec, -1
  s_nop 3
  v_add_f32_dpp v14, v8, v8 row_ror:8 row_mask:0xf bank_mask:0xf
  v_cvt_pk_bf16_f32 v14, v14, v14
  v_and_b32 v14, 0xffff0000, v14
  v_add_f32 v14, v14, v46
  v_cvt_pk_bf16_f32 v14, v14, v14
  s_mov_b32 exec_lo, 0x00ff00ff
  s_mov_b32 exec_hi, 0x00ff00ff
  buffer_store_short v14, v52, s[40:43], 0 offen
  s_branch L_s_end
L_epoch:
  s_cmp_eq_u32 s3, 7
  s_cbranch_scc0 L_s_end
  s_cmp_eq_u32 s2, 63
  s_cbranch_scc0 L_s_end
  v_mov_b32 v3, 0
  s_mov_b64 exec, 1
  buffer_store_dwordx2 v[40:41], v3, s[48:51], 0 offen sc1
L_s_end:
  s_cmp_eq_u32 s50, 0
  s_cbranch_scc1 L_real
  s_endpgm
.section .rodata,"a"
.p2align 6
.amdhsa_kernel sequential_preLN__mha_block_cached__geglu_ffn__decode_kernel
  .amdhsa_next_free_vgpr 256
  .amdhsa_next_free_sgpr 102
  .amdhsa_accum_offset 256
  .amdhsa_group_segment_fixed_size 0
  .amdhsa_kernarg_size 96
  .amdhsa_user_sgpr_count 2
  .amdhsa_user_sgpr_kernarg_segment_ptr 1
  .amdhsa_system_sgpr_workgroup_id_x 1
.end_amdhsa_kernel
```
